```python
import torch

def _softmax(x, axis=-1):
    return torch.softmax(x, dim=axis)
def _gelu(x):
    return torch.nn.functional.gelu(x, approximate="tanh")
def _silu(x):
    return torch.nn.functional.silu(x)
def _sigmoid(x):
    return torch.sigmoid(x)
def _layernorm(x, axis=-1, eps=1e-5):
    m = x.mean(dim=axis, keepdim=True)
    v = x.var(dim=axis, keepdim=True, unbiased=False)
    return (x - m) / torch.sqrt(v + eps)
def _scatter_add(tgt, idx, src, axis=0):
    return tgt.clone().index_add_(axis, idx, src)
def _segment_sum(src, seg, n):
    out = torch.zeros((n,) + src.shape[1:], dtype=src.dtype)
    return out.index_add_(0, seg, src)
def _pad(x, pw):
    flat = tuple(v for pair in reversed(pw) for v in pair)
    return torch.nn.functional.pad(x, flat)

kernel_name = 'concat_heads__sliding_local_dilated__grouped_kv_mqa__prompt'

def setup_inputs():

    _w = (lambda a: (lambda t: t.to(torch.bfloat16) if t.is_floating_point() else t)(torch.as_tensor(a)))
    def _A_setup():
        B, S, D = 1, 2048, 576
        return {
            "x": _w((lambda *s: torch.randn(*s, dtype=torch.bfloat16) * 0.1)(B, S, D)),
            "wqkv": _w((lambda *s: torch.randn(*s, dtype=torch.bfloat16) * 0.8)(D, 3 * D)),
            "wo": _w((lambda *s: torch.randn(*s, dtype=torch.bfloat16) * 0.8)(D, D)),
        }
    _A_in = _A_setup()

    def _B_setup():
        B, S, D, H = 1, 2048, 576, 32
        Dh = D // H
        return {
            "x": _w((lambda *s: torch.randn(*s, dtype=torch.bfloat16) * 0.05)(B, S, D)),
            "wq": _w((lambda *s: torch.randn(*s, dtype=torch.bfloat16) * 3.2)(D, H * Dh)),
            "wk": _w((lambda *s: torch.randn(*s, dtype=torch.bfloat16) * 3.2)(D, Dh)),
            "wv": _w((lambda *s: torch.randn(*s, dtype=torch.bfloat16) * 1.6)(D, Dh)),
            "wo": _w((lambda *s: torch.randn(*s, dtype=torch.bfloat16) * 1.6)(H * Dh, D)),
        }
    _B_in = _B_setup()

    return {
        "A_x": _A_in["x"],
        "A_wqkv": _A_in["wqkv"],
        "A_wo": _A_in["wo"],
        "B_x": _B_in["x"],
        "B_wq": _B_in["wq"],
        "B_wk": _B_in["wk"],
        "B_wv": _B_in["wv"],
        "B_wo": _B_in["wo"],
    }

def reference(A_x, A_wqkv, A_wo, B_x, B_wq, B_wk, B_wv, B_wo):
    def _A_ref(x, wqkv, wo):
        B, S, D = x.shape
        H = 32; Dh = D // H
        W, dil = 8, 2
        qkv = (lambda x, *d: x.permute(*d))((x @ wqkv).reshape(B, S, 3, H, Dh), 2, 0, 3, 1, 4)
        q, k, v = qkv[0], qkv[1], qkv[2]
        scale = Dh ** -0.5
        pos = torch.arange(S)
        off = torch.arange(W) * dil
        idx = pos[:, None] - off[None, :]
        mask = idx >= 0
        idx_c = torch.where(mask, idx, 0).reshape(-1)
        kg = k[:, :, idx_c, :].reshape(B, H, S, W, Dh)
        vg = v[:, :, idx_c, :].reshape(B, H, S, W, Dh)
        logits = torch.einsum("bhsd,bhswd->bhsw", q, kg) * scale
        logits = torch.where(mask[None, None, :, :], logits, -1e9)
        attn = _softmax(logits, axis=-1)
        o = torch.einsum("bhsw,bhswd->bhsd", attn, vg)
        return (lambda x, *d: x.permute(*d))(o, 0, 2, 1, 3).reshape(B, S, D) @ wo

    def _B_ref(x, wq, wk, wv, wo):
        B, S, D = x.shape
        H = 32
        Dh = D // H
        q = (lambda x, *d: x.permute(*d))((x @ wq).reshape(B, S, H, Dh), 0, 2, 1, 3)
        k = x @ wk
        v = x @ wv
        scores = torch.einsum("bhqd,bkd->bhqk", q, k) * (Dh ** -0.5)
        p = _softmax(scores, axis=-1)
        o = torch.einsum("bhqk,bkd->bhqd", p, v)
        return (lambda x, *d: x.permute(*d))(o, 0, 2, 1, 3).reshape(B, S, H * Dh) @ wo

    a = _A_ref(A_x, A_wqkv, A_wo)
    b = _B_ref(B_x, B_wq, B_wk, B_wv, B_wo)
    return torch.concatenate([a, b], axis=-1)
```

```asm
; @launch kernel=projb_kernel grid=(224,1,1) block=(384,1,1) lds=163840
; @launch kernel=main_kernel grid=(512,1,1) block=(512,1,1) lds=81920
; @launch kernel=outp_kernel grid=(192,1,1) block=(768,1,1) lds=143360
.amdgcn_target "amdgcn-amd-amdhsa--gfx950"
.text

.globl projb_kernel
.p2align 8
.type projb_kernel,@function
projb_kernel:
    s_cmp_ge_u32 s2, 224
    s_cbranch_scc1 L_pb_end
    s_load_dwordx4 s[40:43], s[0:1], 0
    s_load_dwordx8 s[44:51], s[0:1], 16
    s_load_dwordx2 s[52:53], s[0:1], 48
    s_load_dwordx2 s[56:57], s[0:1], 80
    v_lshrrev_b32 v1, 6, v0
    s_and_b32 s3, s2, 7
    v_readfirstlane_b32 s27, v1
    s_lshr_b32 s4, s2, 3
    s_and_b32 s5, s4, 3
    s_lshl_b32 s26, s3, 2
    s_add_u32 s26, s26, s5
    s_mul_i32 s20, s26, 73728
    s_cmp_ge_u32 s4, 24
    s_cbranch_scc1 L_pb_KV
    s_lshr_b32 s6, s4, 2
    s_mul_i32 s21, s6, 192
    s_mov_b32 s22, 1152
    s_add_u32 s23, s20, s21
    s_add_u32 s23, s23, 0
    s_mov_b32 s24, 1152
    s_mov_b32 s25, 3
    s_cmp_ge_u32 s27, 4
    s_cbranch_scc1 L_pq_w4
    v_and_b32 v1, 63, v0
    s_lshl_b32 s29, s27, 3
    v_lshrrev_b32 v6, 3, v1
    v_add_u32 v6, s29, v6
    v_mul_u32_u24 v6, 1152, v6
    v_lshrrev_b32 v7, 4, v1
    s_lshl_b32 s29, s27, 2
    v_add_u32 v7, s29, v7
    v_and_b32 v7, 7, v7
    v_and_b32 v8, 7, v1
    v_xor_b32 v7, v7, v8
    v_lshl_add_u32 v67, v7, 4, v6
    v_add_u32 v68, 36864, v67
    s_lshl_b32 s33, s27, 10
    s_add_u32 s33, s33, 98304
    s_mov_b32 s28, 22369622
    v_lshlrev_b32 v6, 4, v1
    v_mul_hi_u32 v7, v6, s28
    v_mul_u32_u24 v8, 192, v7
    v_sub_u32 v8, v6, v8
    v_mul_lo_u32 v7, v7, s22
    v_add_u32 v64, v7, v8
    v_lshlrev_b32 v6, 4, v1
    v_add_u32 v6, 1024, v6
    v_mul_hi_u32 v7, v6, s28
    v_mul_u32_u24 v8, 192, v7
    v_sub_u32 v8, v6, v8
    v_mul_lo_u32 v7, v7, s22
    v_add_u32 v65, v7, v8
    v_lshlrev_b32 v6, 4, v1
    v_add_u32 v6, 2048, v6
    v_mul_hi_u32 v7, v6, s28
    v_mul_u32_u24 v8, 192, v7
    v_sub_u32 v8, v6, v8
    v_mul_lo_u32 v7, v7, s22
    v_add_u32 v66, v7, v8
    s_lshl_b32 s31, s22, 4
    s_mul_i32 s30, s31, s27
    s_add_u32 s30, s30, s21
    s_lshl_b32 s31, s22, 6
    s_mul_i32 s32, s27, 3072
    s_waitcnt lgkmcnt(0)
    s_mov_b32 s8, s46
    s_mov_b32 s9, s47
    s_mov_b32 s10, 2359296
    s_mov_b32 s11, 0x00020000
    s_mov_b32 s12, s48
    s_mov_b32 s13, s49
    s_mov_b32 s14, 663552
    s_mov_b32 s15, 0x00020000
    s_mov_b32 s16, s56
    s_mov_b32 s17, s57
    s_mov_b32 s18, 16777216
    s_mov_b32 s19, 0x00020000
    s_add_u32 m0, s32, 0
    s_nop 0
    buffer_load_dwordx4 v64, s[12:15], s30 offen lds
    s_add_u32 m0, s32, 1024
    s_nop 0
    buffer_load_dwordx4 v65, s[12:15], s30 offen lds
    s_add_u32 m0, s32, 2048
    s_nop 0
    buffer_load_dwordx4 v66, s[12:15], s30 offen lds
    s_add_u32 s30, s30, s31
    s_add_u32 m0, s33, 0
    s_nop 0
    buffer_load_dwordx4 v67, s[8:11], s20 offen lds
    s_add_u32 m0, s33, 4096
    s_nop 0
    buffer_load_dwordx4 v68, s[8:11], s20 offen lds
    s_add_u32 s20, s20, 128
    s_add_u32 m0, s32, 12288
    s_nop 0
    buffer_load_dwordx4 v64, s[12:15], s30 offen lds
    s_add_u32 m0, s32, 13312
    s_nop 0
    buffer_load_dwordx4 v65, s[12:15], s30 offen lds
    s_add_u32 m0, s32, 14336
    s_nop 0
    buffer_load_dwordx4 v66, s[12:15], s30 offen lds
    s_add_u32 s30, s30, s31
    s_add_u32 m0, s33, 8192
    s_nop 0
    buffer_load_dwordx4 v67, s[8:11], s20 offen lds
    s_add_u32 m0, s33, 12288
    s_nop 0
    buffer_load_dwordx4 v68, s[8:11], s20 offen lds
    s_add_u32 s20, s20, 128
    s_add_u32 m0, s32, 24576
    s_nop 0
    buffer_load_dwordx4 v64, s[12:15], s30 offen lds
    s_add_u32 m0, s32, 25600
    s_nop 0
    buffer_load_dwordx4 v65, s[12:15], s30 offen lds
    s_add_u32 m0, s32, 26624
    s_nop 0
    buffer_load_dwordx4 v66, s[12:15], s30 offen lds
    s_add_u32 s30, s30, s31
    s_add_u32 m0, s33, 16384
    s_nop 0
    buffer_load_dwordx4 v67, s[8:11], s20 offen lds
    s_add_u32 m0, s33, 20480
    s_nop 0
    buffer_load_dwordx4 v68, s[8:11], s20 offen lds
    s_add_u32 s20, s20, 128
    s_add_u32 m0, s32, 36864
    s_nop 0
    buffer_load_dwordx4 v64, s[12:15], s30 offen lds
    s_add_u32 m0, s32, 37888
    s_nop 0
    buffer_load_dwordx4 v65, s[12:15], s30 offen lds
    s_add_u32 m0, s32, 38912
    s_nop 0
    buffer_load_dwordx4 v66, s[12:15], s30 offen lds
    s_add_u32 s30, s30, s31
    s_add_u32 m0, s33, 24576
    s_nop 0
    buffer_load_dwordx4 v67, s[8:11], s20 offen lds
    s_add_u32 m0, s33, 28672
    s_nop 0
    buffer_load_dwordx4 v68, s[8:11], s20 offen lds
    s_add_u32 s20, s20, 128
    s_add_u32 m0, s32, 49152
    s_nop 0
    buffer_load_dwordx4 v64, s[12:15], s30 offen lds
    s_add_u32 m0, s32, 50176
    s_nop 0
    buffer_load_dwordx4 v65, s[12:15], s30 offen lds
    s_add_u32 m0, s32, 51200
    s_nop 0
    buffer_load_dwordx4 v66, s[12:15], s30 offen lds
    s_add_u32 s30, s30, s31
    s_add_u32 m0, s33, 32768
    s_nop 0
    buffer_load_dwordx4 v67, s[8:11], s20 offen lds
    s_add_u32 m0, s33, 36864
    s_nop 0
    buffer_load_dwordx4 v68, s[8:11], s20 offen lds
    s_add_u32 s20, s20, 128
    s_add_u32 m0, s32, 61440
    s_nop 0
    buffer_load_dwordx4 v64, s[12:15], s30 offen lds
    s_add_u32 m0, s32, 62464
    s_nop 0
    buffer_load_dwordx4 v65, s[12:15], s30 offen lds
    s_add_u32 m0, s32, 63488
    s_nop 0
    buffer_load_dwordx4 v66, s[12:15], s30 offen lds
    s_add_u32 s30, s30, s31
    s_add_u32 m0, s33, 40960
    s_nop 0
    buffer_load_dwordx4 v67, s[8:11], s20 offen lds
    s_add_u32 m0, s33, 45056
    s_nop 0
    buffer_load_dwordx4 v68, s[8:11], s20 offen lds
    s_add_u32 s20, s20, 128
    s_add_u32 m0, s32, 73728
    s_nop 0
    buffer_load_dwordx4 v64, s[12:15], s30 offen lds
    s_add_u32 m0, s32, 74752
    s_nop 0
    buffer_load_dwordx4 v65, s[12:15], s30 offen lds
    s_add_u32 m0, s32, 75776
    s_nop 0
    buffer_load_dwordx4 v66, s[12:15], s30 offen lds
    s_add_u32 s30, s30, s31
    s_add_u32 m0, s33, 49152
    s_nop 0
    buffer_load_dwordx4 v67, s[8:11], s20 offen lds
    s_add_u32 m0, s33, 53248
    s_nop 0
    buffer_load_dwordx4 v68, s[8:11], s20 offen lds
    s_add_u32 s20, s20, 128
    s_add_u32 m0, s32, 86016
    s_nop 0
    buffer_load_dwordx4 v64, s[12:15], s30 offen lds
    s_add_u32 m0, s32, 87040
    s_nop 0
    buffer_load_dwordx4 v65, s[12:15], s30 offen lds
    s_add_u32 m0, s32, 88064
    s_nop 0
    buffer_load_dwordx4 v66, s[12:15], s30 offen lds
    s_add_u32 s30, s30, s31
    s_add_u32 m0, s33, 57344
    s_nop 0
    buffer_load_dwordx4 v67, s[8:11], s20 offen lds
    s_add_u32 m0, s33, 61440
    s_nop 0
    buffer_load_dwordx4 v68, s[8:11], s20 offen lds
    s_add_u32 s20, s20, 128
    v_and_b32 v1, 63, v0
    s_and_b32 s34, s27, 1
    s_lshr_b32 s35, s27, 1
    v_lshrrev_b32 v6, 5, v1
    v_lshlrev_b32 v6, 3, v6
    v_bfe_u32 v7, v1, 2, 2
    v_add_u32 v6, v6, v7
    v_mul_u32_u24 v6, 192, v6
    v_bfe_u32 v7, v1, 4, 1
    v_lshlrev_b32 v7, 5, v7
    v_and_b32 v8, 3, v1
    v_lshlrev_b32 v8, 3, v8
    v_add3_u32 v2, v6, v7, v8
    s_mul_i32 s28, s35, 64
    v_add_u32 v2, s28, v2
    v_add_u32 v3, 61440, v2
    v_add_u32 v4, 122880, v2
    v_add_u32 v5, 184320, v2
    v_and_b32 v6, 31, v1
    v_lshrrev_b32 v7, 5, v1
    v_bfe_u32 v8, v1, 1, 3
    v_lshlrev_b32 v10, 7, v6
    s_mul_i32 s28, s34, 4096
    s_add_u32 s28, s28, 98304
    v_add_u32 v10, s28, v10
    v_add_u32 v9, 0, v7
    v_xor_b32 v9, v9, v8
    v_lshl_add_u32 v69, v9, 4, v10
    v_add_u32 v9, 2, v7
    v_xor_b32 v9, v9, v8
    v_lshl_add_u32 v70, v9, 4, v10
    v_add_u32 v9, 4, v7
    v_xor_b32 v9, v9, v8
    v_lshl_add_u32 v71, v9, 4, v10
    v_add_u32 v9, 6, v7
    v_xor_b32 v9, v9, v8
    v_lshl_add_u32 v72, v9, 4, v10
    s_mul_i32 s28, s34, 6656
    s_mul_i32 s29, s35, 64
    s_add_u32 s28, s28, s29
    v_mul_u32_u24 v6, 208, v6
    v_lshl_add_u32 v6, v7, 4, v6
    v_add_u32 v77, s28, v6
    s_waitcnt vmcnt(35)
    s_barrier
    ds_read_b64_tr_b16 v[32:33], v2 offset:0
    ds_read_b64_tr_b16 v[34:35], v2 offset:768
    ds_read_b128 v[48:51], v69 offset:0
    ds_read_b64_tr_b16 v[36:37], v2 offset:3072
    ds_read_b64_tr_b16 v[38:39], v2 offset:3840
    ds_read_b128 v[52:55], v70 offset:0
    ds_read_b64_tr_b16 v[40:41], v2 offset:6144
    ds_read_b64_tr_b16 v[42:43], v2 offset:6912
    ds_read_b128 v[56:59], v71 offset:0
    s_waitcnt lgkmcnt(6)
    v_mfma_f32_32x32x16_bf16 v[16:31], v[32:35], v[48:51], 0
    ds_read_b64_tr_b16 v[44:45], v2 offset:9216
    ds_read_b64_tr_b16 v[46:47], v2 offset:9984
    ds_read_b128 v[60:63], v72 offset:0
    s_waitcnt vmcnt(30)
    s_barrier
    s_waitcnt lgkmcnt(6)
    v_mfma_f32_32x32x16_bf16 v[16:31], v[36:39], v[52:55], v[16:31]
    ds_read_b64_tr_b16 v[32:33], v2 offset:12288
    ds_read_b64_tr_b16 v[34:35], v2 offset:13056
    ds_read_b128 v[48:51], v69 offset:8192
    s_waitcnt lgkmcnt(6)
    v_mfma_f32_32x32x16_bf16 v[16:31], v[40:43], v[56:59], v[16:31]
    ds_read_b64_tr_b16 v[36:37], v2 offset:15360
    ds_read_b64_tr_b16 v[38:39], v2 offset:16128
    ds_read_b128 v[52:55], v70 offset:8192
    s_waitcnt lgkmcnt(6)
    v_mfma_f32_32x32x16_bf16 v[16:31], v[44:47], v[60:63], v[16:31]
    ds_read_b64_tr_b16 v[40:41], v2 offset:18432
    ds_read_b64_tr_b16 v[42:43], v2 offset:19200
    ds_read_b128 v[56:59], v71 offset:8192
    s_waitcnt lgkmcnt(6)
    v_mfma_f32_32x32x16_bf16 v[16:31], v[32:35], v[48:51], v[16:31]
    ds_read_b64_tr_b16 v[44:45], v2 offset:21504
    ds_read_b64_tr_b16 v[46:47], v2 offset:22272
    ds_read_b128 v[60:63], v72 offset:8192
    s_waitcnt vmcnt(25)
    s_barrier
    s_waitcnt lgkmcnt(6)
    v_mfma_f32_32x32x16_bf16 v[16:31], v[36:39], v[52:55], v[16:31]
    ds_read_b64_tr_b16 v[32:33], v2 offset:24576
    ds_read_b64_tr_b16 v[34:35], v2 offset:25344
    ds_read_b128 v[48:51], v69 offset:16384
    s_add_u32 m0, s32, 0
    s_nop 0
    buffer_load_dwordx4 v64, s[12:15], s30 offen lds
    s_add_u32 m0, s32, 1024
    s_nop 0
    buffer_load_dwordx4 v65, s[12:15], s30 offen lds
    s_waitcnt lgkmcnt(6)
    v_mfma_f32_32x32x16_bf16 v[16:31], v[40:43], v[56:59], v[16:31]
    ds_read_b64_tr_b16 v[36:37], v2 offset:27648
    ds_read_b64_tr_b16 v[38:39], v2 offset:28416
    ds_read_b128 v[52:55], v70 offset:16384
    s_add_u32 m0, s32, 2048
    s_nop 0
    buffer_load_dwordx4 v66, s[12:15], s30 offen lds
    s_add_u32 s30, s30, s31
    s_waitcnt lgkmcnt(6)
    v_mfma_f32_32x32x16_bf16 v[16:31], v[44:47], v[60:63], v[16:31]
    ds_read_b64_tr_b16 v[40:41], v2 offset:30720
    ds_read_b64_tr_b16 v[42:43], v2 offset:31488
    ds_read_b128 v[56:59], v71 offset:16384
    s_add_u32 m0, s33, 0
    s_nop 0
    buffer_load_dwordx4 v67, s[8:11], s20 offen lds
    s_waitcnt lgkmcnt(6)
    v_mfma_f32_32x32x16_bf16 v[16:31], v[32:35], v[48:51], v[16:31]
    ds_read_b64_tr_b16 v[44:45], v2 offset:33792
    ds_read_b64_tr_b16 v[46:47], v2 offset:34560
    ds_read_b128 v[60:63], v72 offset:16384
    s_add_u32 m0, s33, 4096
    s_nop 0
    buffer_load_dwordx4 v68, s[8:11], s20 offen lds
    s_add_u32 s20, s20, 128
    s_waitcnt vmcnt(25)
    s_barrier
    s_waitcnt lgkmcnt(6)
    v_mfma_f32_32x32x16_bf16 v[16:31], v[36:39], v[52:55], v[16:31]
    ds_read_b64_tr_b16 v[32:33], v2 offset:36864
    ds_read_b64_tr_b16 v[34:35], v2 offset:37632
    ds_read_b128 v[48:51], v69 offset:24576
    s_waitcnt lgkmcnt(6)
    v_mfma_f32_32x32x16_bf16 v[16:31], v[40:43], v[56:59], v[16:31]
    ds_read_b64_tr_b16 v[36:37], v2 offset:39936
    ds_read_b64_tr_b16 v[38:39], v2 offset:40704
    ds_read_b128 v[52:55], v70 offset:24576
    s_waitcnt lgkmcnt(6)
    v_mfma_f32_32x32x16_bf16 v[16:31], v[44:47], v[60:63], v[16:31]
    ds_read_b64_tr_b16 v[40:41], v2 offset:43008
    ds_read_b64_tr_b16 v[42:43], v2 offset:43776
    ds_read_b128 v[56:59], v71 offset:24576
    s_waitcnt lgkmcnt(6)
    v_mfma_f32_32x32x16_bf16 v[16:31], v[32:35], v[48:51], v[16:31]
    ds_read_b64_tr_b16 v[44:45], v2 offset:46080
    ds_read_b64_tr_b16 v[46:47], v2 offset:46848
    ds_read_b128 v[60:63], v72 offset:24576
    s_waitcnt vmcnt(20)
    s_barrier
    s_waitcnt lgkmcnt(6)
    v_mfma_f32_32x32x16_bf16 v[16:31], v[36:39], v[52:55], v[16:31]
    ds_read_b64_tr_b16 v[32:33], v2 offset:49152
    ds_read_b64_tr_b16 v[34:35], v2 offset:49920
    ds_read_b128 v[48:51], v69 offset:32768
    s_waitcnt lgkmcnt(6)
    v_mfma_f32_32x32x16_bf16 v[16:31], v[40:43], v[56:59], v[16:31]
    ds_read_b64_tr_b16 v[36:37], v2 offset:52224
    ds_read_b64_tr_b16 v[38:39], v2 offset:52992
    ds_read_b128 v[52:55], v70 offset:32768
    s_waitcnt lgkmcnt(6)
    v_mfma_f32_32x32x16_bf16 v[16:31], v[44:47], v[60:63], v[16:31]
    ds_read_b64_tr_b16 v[40:41], v2 offset:55296
    ds_read_b64_tr_b16 v[42:43], v2 offset:56064
    ds_read_b128 v[56:59], v71 offset:32768
    s_waitcnt lgkmcnt(6)
    v_mfma_f32_32x32x16_bf16 v[16:31], v[32:35], v[48:51], v[16:31]
    ds_read_b64_tr_b16 v[44:45], v2 offset:58368
    ds_read_b64_tr_b16 v[46:47], v2 offset:59136
    ds_read_b128 v[60:63], v72 offset:32768
    s_waitcnt vmcnt(15)
    s_barrier
    s_waitcnt lgkmcnt(6)
    v_mfma_f32_32x32x16_bf16 v[16:31], v[36:39], v[52:55], v[16:31]
    ds_read_b64_tr_b16 v[32:33], v3 offset:0
    ds_read_b64_tr_b16 v[34:35], v3 offset:768
    ds_read_b128 v[48:51], v69 offset:40960
    s_waitcnt lgkmcnt(6)
    v_mfma_f32_32x32x16_bf16 v[16:31], v[40:43], v[56:59], v[16:31]
    ds_read_b64_tr_b16 v[36:37], v3 offset:3072
    ds_read_b64_tr_b16 v[38:39], v3 offset:3840
    ds_read_b128 v[52:55], v70 offset:40960
    s_waitcnt lgkmcnt(6)
    v_mfma_f32_32x32x16_bf16 v[16:31], v[44:47], v[60:63], v[16:31]
    ds_read_b64_tr_b16 v[40:41], v3 offset:6144
    ds_read_b64_tr_b16 v[42:43], v3 offset:6912
    ds_read_b128 v[56:59], v71 offset:40960
    s_waitcnt lgkmcnt(6)
    v_mfma_f32_32x32x16_bf16 v[16:31], v[32:35], v[48:51], v[16:31]
    ds_read_b64_tr_b16 v[44:45], v3 offset:9216
    ds_read_b64_tr_b16 v[46:47], v3 offset:9984
    ds_read_b128 v[60:63], v72 offset:40960
    s_waitcnt vmcnt(10)
    s_barrier
    s_waitcnt lgkmcnt(6)
    v_mfma_f32_32x32x16_bf16 v[16:31], v[36:39], v[52:55], v[16:31]
    ds_read_b64_tr_b16 v[32:33], v3 offset:12288
    ds_read_b64_tr_b16 v[34:35], v3 offset:13056
    ds_read_b128 v[48:51], v69 offset:49152
    s_waitcnt lgkmcnt(6)
    v_mfma_f32_32x32x16_bf16 v[16:31], v[40:43], v[56:59], v[16:31]
    ds_read_b64_tr_b16 v[36:37], v3 offset:15360
    ds_read_b64_tr_b16 v[38:39], v3 offset:16128
    ds_read_b128 v[52:55], v70 offset:49152
    s_waitcnt lgkmcnt(6)
    v_mfma_f32_32x32x16_bf16 v[16:31], v[44:47], v[60:63], v[16:31]
    ds_read_b64_tr_b16 v[40:41], v3 offset:18432
    ds_read_b64_tr_b16 v[42:43], v3 offset:19200
    ds_read_b128 v[56:59], v71 offset:49152
    s_waitcnt lgkmcnt(6)
    v_mfma_f32_32x32x16_bf16 v[16:31], v[32:35], v[48:51], v[16:31]
    ds_read_b64_tr_b16 v[44:45], v3 offset:21504
    ds_read_b64_tr_b16 v[46:47], v3 offset:22272
    ds_read_b128 v[60:63], v72 offset:49152
    s_waitcnt vmcnt(5)
    s_barrier
    s_waitcnt lgkmcnt(6)
    v_mfma_f32_32x32x16_bf16 v[16:31], v[36:39], v[52:55], v[16:31]
    ds_read_b64_tr_b16 v[32:33], v3 offset:24576
    ds_read_b64_tr_b16 v[34:35], v3 offset:25344
    ds_read_b128 v[48:51], v69 offset:57344
    s_waitcnt lgkmcnt(6)
    v_mfma_f32_32x32x16_bf16 v[16:31], v[40:43], v[56:59], v[16:31]
    ds_read_b64_tr_b16 v[36:37], v3 offset:27648
    ds_read_b64_tr_b16 v[38:39], v3 offset:28416
    ds_read_b128 v[52:55], v70 offset:57344
    s_waitcnt lgkmcnt(6)
    v_mfma_f32_32x32x16_bf16 v[16:31], v[44:47], v[60:63], v[16:31]
    ds_read_b64_tr_b16 v[40:41], v3 offset:30720
    ds_read_b64_tr_b16 v[42:43], v3 offset:31488
    ds_read_b128 v[56:59], v71 offset:57344
    s_waitcnt lgkmcnt(6)
    v_mfma_f32_32x32x16_bf16 v[16:31], v[32:35], v[48:51], v[16:31]
    ds_read_b64_tr_b16 v[44:45], v3 offset:33792
    ds_read_b64_tr_b16 v[46:47], v3 offset:34560
    ds_read_b128 v[60:63], v72 offset:57344
    s_waitcnt vmcnt(0)
    s_barrier
    s_waitcnt lgkmcnt(6)
    v_mfma_f32_32x32x16_bf16 v[16:31], v[36:39], v[52:55], v[16:31]
    ds_read_b64_tr_b16 v[32:33], v2 offset:0
    ds_read_b64_tr_b16 v[34:35], v2 offset:768
    ds_read_b128 v[48:51], v69 offset:0
    s_waitcnt lgkmcnt(6)
    v_mfma_f32_32x32x16_bf16 v[16:31], v[40:43], v[56:59], v[16:31]
    ds_read_b64_tr_b16 v[36:37], v2 offset:3072
    ds_read_b64_tr_b16 v[38:39], v2 offset:3840
    ds_read_b128 v[52:55], v70 offset:0
    s_waitcnt lgkmcnt(6)
    v_mfma_f32_32x32x16_bf16 v[16:31], v[44:47], v[60:63], v[16:31]
    ds_read_b64_tr_b16 v[40:41], v2 offset:6144
    ds_read_b64_tr_b16 v[42:43], v2 offset:6912
    ds_read_b128 v[56:59], v71 offset:0
    s_waitcnt lgkmcnt(6)
    v_mfma_f32_32x32x16_bf16 v[16:31], v[32:35], v[48:51], v[16:31]
    ds_read_b64_tr_b16 v[44:45], v2 offset:9216
    ds_read_b64_tr_b16 v[46:47], v2 offset:9984
    ds_read_b128 v[60:63], v72 offset:0
    s_waitcnt lgkmcnt(6)
    v_mfma_f32_32x32x16_bf16 v[16:31], v[36:39], v[52:55], v[16:31]
    s_waitcnt lgkmcnt(3)
    v_mfma_f32_32x32x16_bf16 v[16:31], v[40:43], v[56:59], v[16:31]
    s_waitcnt lgkmcnt(0)
    v_mfma_f32_32x32x16_bf16 v[16:31], v[44:47], v[60:63], v[16:31]
    s_barrier
    s_mov_b32 s28, 0x3eae1a93
    s_nop 12
    v_cvt_pk_bf16_f32 v32, v16, v17
    v_cvt_pk_bf16_f32 v33, v18, v19
    v_cvt_pk_bf16_f32 v34, v20, v21
    v_cvt_pk_bf16_f32 v35, v22, v23
    v_cvt_pk_bf16_f32 v36, v24, v25
    v_cvt_pk_bf16_f32 v37, v26, v27
    v_cvt_pk_bf16_f32 v38, v28, v29
    v_cvt_pk_bf16_f32 v39, v30, v31
    v_lshlrev_b32 v16, 16, v32
    v_and_b32 v17, 0xffff0000, v32
    v_mul_f32 v16, s28, v16
    v_mul_f32 v17, s28, v17
    v_cvt_pk_bf16_f32 v32, v16, v17
    v_lshlrev_b32 v18, 16, v33
    v_and_b32 v19, 0xffff0000, v33
    v_mul_f32 v18, s28, v18
    v_mul_f32 v19, s28, v19
    v_cvt_pk_bf16_f32 v33, v18, v19
    v_lshlrev_b32 v20, 16, v34
    v_and_b32 v21, 0xffff0000, v34
    v_mul_f32 v20, s28, v20
    v_mul_f32 v21, s28, v21
    v_cvt_pk_bf16_f32 v34, v20, v21
    v_lshlrev_b32 v22, 16, v35
    v_and_b32 v23, 0xffff0000, v35
    v_mul_f32 v22, s28, v22
    v_mul_f32 v23, s28, v23
    v_cvt_pk_bf16_f32 v35, v22, v23
    v_lshlrev_b32 v24, 16, v36
    v_and_b32 v25, 0xffff0000, v36
    v_mul_f32 v24, s28, v24
    v_mul_f32 v25, s28, v25
    v_cvt_pk_bf16_f32 v36, v24, v25
    v_lshlrev_b32 v26, 16, v37
    v_and_b32 v27, 0xffff0000, v37
    v_mul_f32 v26, s28, v26
    v_mul_f32 v27, s28, v27
    v_cvt_pk_bf16_f32 v37, v26, v27
    v_lshlrev_b32 v28, 16, v38
    v_and_b32 v29, 0xffff0000, v38
    v_mul_f32 v28, s28, v28
    v_mul_f32 v29, s28, v29
    v_cvt_pk_bf16_f32 v38, v28, v29
    v_lshlrev_b32 v30, 16, v39
    v_and_b32 v31, 0xffff0000, v39
    v_mul_f32 v30, s28, v30
    v_mul_f32 v31, s28, v31
    v_cvt_pk_bf16_f32 v39, v30, v31
    s_nop 1
    v_permlane32_swap_b32 v32, v34
    v_permlane32_swap_b32 v33, v35
    v_permlane32_swap_b32 v36, v38
    v_permlane32_swap_b32 v37, v39
    ds_write_b128 v77, v[32:35] offset:0
    ds_write_b128 v77, v[36:39] offset:32
    s_waitcnt lgkmcnt(0)
    s_branch L_pq_fin
L_pq_w4:
    s_waitcnt lgkmcnt(0)
    s_mov_b32 s8, s46
    s_mov_b32 s9, s47
    s_mov_b32 s10, 2359296
    s_mov_b32 s11, 0x00020000
    s_mov_b32 s12, s48
    s_mov_b32 s13, s49
    s_mov_b32 s14, 663552
    s_mov_b32 s15, 0x00020000
    s_mov_b32 s16, s56
    s_mov_b32 s17, s57
    s_mov_b32 s18, 16777216
    s_mov_b32 s19, 0x00020000
    v_and_b32 v1, 63, v0
    s_and_b32 s34, s27, 1
    s_lshr_b32 s35, s27, 1
    v_lshrrev_b32 v6, 5, v1
    v_lshlrev_b32 v6, 3, v6
    v_bfe_u32 v7, v1, 2, 2
    v_add_u32 v6, v6, v7
    v_mul_u32_u24 v6, 192, v6
    v_bfe_u32 v7, v1, 4, 1
    v_lshlrev_b32 v7, 5, v7
    v_and_b32 v8, 3, v1
    v_lshlrev_b32 v8, 3, v8
    v_add3_u32 v2, v6, v7, v8
    s_mul_i32 s28, s35, 64
    v_add_u32 v2, s28, v2
    v_add_u32 v3, 61440, v2
    v_add_u32 v4, 122880, v2
    v_add_u32 v5, 184320, v2
    v_and_b32 v6, 31, v1
    v_lshrrev_b32 v7, 5, v1
    v_bfe_u32 v8, v1, 1, 3
    v_lshlrev_b32 v10, 7, v6
    s_mul_i32 s28, s34, 4096
    s_add_u32 s28, s28, 98304
    v_add_u32 v10, s28, v10
    v_add_u32 v9, 0, v7
    v_xor_b32 v9, v9, v8
    v_lshl_add_u32 v69, v9, 4, v10
    v_add_u32 v9, 2, v7
    v_xor_b32 v9, v9, v8
    v_lshl_add_u32 v70, v9, 4, v10
    v_add_u32 v9, 4, v7
    v_xor_b32 v9, v9, v8
    v_lshl_add_u32 v71, v9, 4, v10
    v_add_u32 v9, 6, v7
    v_xor_b32 v9, v9, v8
    v_lshl_add_u32 v72, v9, 4, v10
    s_mul_i32 s28, s34, 6656
    s_mul_i32 s29, s35, 64
    s_add_u32 s28, s28, s29
    v_mul_u32_u24 v6, 208, v6
    v_lshl_add_u32 v6, v7, 4, v6
    v_add_u32 v77, s28, v6
    s_barrier
    ds_read_b64_tr_b16 v[32:33], v2 offset:0
    ds_read_b64_tr_b16 v[34:35], v2 offset:768
    ds_read_b128 v[48:51], v69 offset:0
    ds_read_b64_tr_b16 v[36:37], v2 offset:3072
    ds_read_b64_tr_b16 v[38:39], v2 offset:3840
    ds_read_b128 v[52:55], v70 offset:0
    ds_read_b64_tr_b16 v[40:41], v2 offset:6144
    ds_read_b64_tr_b16 v[42:43], v2 offset:6912
    ds_read_b128 v[56:59], v71 offset:0
    s_waitcnt lgkmcnt(6)
    v_mfma_f32_32x32x16_bf16 v[16:31], v[32:35], v[48:51], 0
    ds_read_b64_tr_b16 v[44:45], v2 offset:9216
    ds_read_b64_tr_b16 v[46:47], v2 offset:9984
    ds_read_b128 v[60:63], v72 offset:0
    s_barrier
    s_waitcnt lgkmcnt(6)
    v_mfma_f32_32x32x16_bf16 v[16:31], v[36:39], v[52:55], v[16:31]
    ds_read_b64_tr_b16 v[32:33], v2 offset:12288
    ds_read_b64_tr_b16 v[34:35], v2 offset:13056
    ds_read_b128 v[48:51], v69 offset:8192
    s_waitcnt lgkmcnt(6)
    v_mfma_f32_32x32x16_bf16 v[16:31], v[40:43], v[56:59], v[16:31]
    ds_read_b64_tr_b16 v[36:37], v2 offset:15360
    ds_read_b64_tr_b16 v[38:39], v2 offset:16128
    ds_read_b128 v[52:55], v70 offset:8192
    s_waitcnt lgkmcnt(6)
    v_mfma_f32_32x32x16_bf16 v[16:31], v[44:47], v[60:63], v[16:31]
    ds_read_b64_tr_b16 v[40:41], v2 offset:18432
    ds_read_b64_tr_b16 v[42:43], v2 offset:19200
    ds_read_b128 v[56:59], v71 offset:8192
    s_waitcnt lgkmcnt(6)
    v_mfma_f32_32x32x16_bf16 v[16:31], v[32:35], v[48:51], v[16:31]
    ds_read_b64_tr_b16 v[44:45], v2 offset:21504
    ds_read_b64_tr_b16 v[46:47], v2 offset:22272
    ds_read_b128 v[60:63], v72 offset:8192
    s_barrier
    s_waitcnt lgkmcnt(6)
    v_mfma_f32_32x32x16_bf16 v[16:31], v[36:39], v[52:55], v[16:31]
    ds_read_b64_tr_b16 v[32:33], v2 offset:24576
    ds_read_b64_tr_b16 v[34:35], v2 offset:25344
    ds_read_b128 v[48:51], v69 offset:16384
    s_waitcnt lgkmcnt(6)
    v_mfma_f32_32x32x16_bf16 v[16:31], v[40:43], v[56:59], v[16:31]
    ds_read_b64_tr_b16 v[36:37], v2 offset:27648
    ds_read_b64_tr_b16 v[38:39], v2 offset:28416
    ds_read_b128 v[52:55], v70 offset:16384
    s_waitcnt lgkmcnt(6)
    v_mfma_f32_32x32x16_bf16 v[16:31], v[44:47], v[60:63], v[16:31]
    ds_read_b64_tr_b16 v[40:41], v2 offset:30720
    ds_read_b64_tr_b16 v[42:43], v2 offset:31488
    ds_read_b128 v[56:59], v71 offset:16384
    s_waitcnt lgkmcnt(6)
    v_mfma_f32_32x32x16_bf16 v[16:31], v[32:35], v[48:51], v[16:31]
    ds_read_b64_tr_b16 v[44:45], v2 offset:33792
    ds_read_b64_tr_b16 v[46:47], v2 offset:34560
    ds_read_b128 v[60:63], v72 offset:16384
    s_barrier
    s_waitcnt lgkmcnt(6)
    v_mfma_f32_32x32x16_bf16 v[16:31], v[36:39], v[52:55], v[16:31]
    ds_read_b64_tr_b16 v[32:33], v2 offset:36864
    ds_read_b64_tr_b16 v[34:35], v2 offset:37632
    ds_read_b128 v[48:51], v69 offset:24576
    s_waitcnt lgkmcnt(6)
    v_mfma_f32_32x32x16_bf16 v[16:31], v[40:43], v[56:59], v[16:31]
    ds_read_b64_tr_b16 v[36:37], v2 offset:39936
    ds_read_b64_tr_b16 v[38:39], v2 offset:40704
    ds_read_b128 v[52:55], v70 offset:24576
    s_waitcnt lgkmcnt(6)
    v_mfma_f32_32x32x16_bf16 v[16:31], v[44:47], v[60:63], v[16:31]
    ds_read_b64_tr_b16 v[40:41], v2 offset:43008
    ds_read_b64_tr_b16 v[42:43], v2 offset:43776
    ds_read_b128 v[56:59], v71 offset:24576
    s_waitcnt lgkmcnt(6)
    v_mfma_f32_32x32x16_bf16 v[16:31], v[32:35], v[48:51], v[16:31]
    ds_read_b64_tr_b16 v[44:45], v2 offset:46080
    ds_read_b64_tr_b16 v[46:47], v2 offset:46848
    ds_read_b128 v[60:63], v72 offset:24576
    s_barrier
    s_waitcnt lgkmcnt(6)
    v_mfma_f32_32x32x16_bf16 v[16:31], v[36:39], v[52:55], v[16:31]
    ds_read_b64_tr_b16 v[32:33], v2 offset:49152
    ds_read_b64_tr_b16 v[34:35], v2 offset:49920
    ds_read_b128 v[48:51], v69 offset:32768
    s_waitcnt lgkmcnt(6)
    v_mfma_f32_32x32x16_bf16 v[16:31], v[40:43], v[56:59], v[16:31]
    ds_read_b64_tr_b16 v[36:37], v2 offset:52224
    ds_read_b64_tr_b16 v[38:39], v2 offset:52992
    ds_read_b128 v[52:55], v70 offset:32768
    s_waitcnt lgkmcnt(6)
    v_mfma_f32_32x32x16_bf16 v[16:31], v[44:47], v[60:63], v[16:31]
    ds_read_b64_tr_b16 v[40:41], v2 offset:55296
    ds_read_b64_tr_b16 v[42:43], v2 offset:56064
    ds_read_b128 v[56:59], v71 offset:32768
    s_waitcnt lgkmcnt(6)
    v_mfma_f32_32x32x16_bf16 v[16:31], v[32:35], v[48:51], v[16:31]
    ds_read_b64_tr_b16 v[44:45], v2 offset:58368
    ds_read_b64_tr_b16 v[46:47], v2 offset:59136
    ds_read_b128 v[60:63], v72 offset:32768
    s_barrier
    s_waitcnt lgkmcnt(6)
    v_mfma_f32_32x32x16_bf16 v[16:31], v[36:39], v[52:55], v[16:31]
    ds_read_b64_tr_b16 v[32:33], v3 offset:0
    ds_read_b64_tr_b16 v[34:35], v3 offset:768
    ds_read_b128 v[48:51], v69 offset:40960
    s_waitcnt lgkmcnt(6)
    v_mfma_f32_32x32x16_bf16 v[16:31], v[40:43], v[56:59], v[16:31]
    ds_read_b64_tr_b16 v[36:37], v3 offset:3072
    ds_read_b64_tr_b16 v[38:39], v3 offset:3840
    ds_read_b128 v[52:55], v70 offset:40960
    s_waitcnt lgkmcnt(6)
    v_mfma_f32_32x32x16_bf16 v[16:31], v[44:47], v[60:63], v[16:31]
    ds_read_b64_tr_b16 v[40:41], v3 offset:6144
    ds_read_b64_tr_b16 v[42:43], v3 offset:6912
    ds_read_b128 v[56:59], v71 offset:40960
    s_waitcnt lgkmcnt(6)
    v_mfma_f32_32x32x16_bf16 v[16:31], v[32:35], v[48:51], v[16:31]
    ds_read_b64_tr_b16 v[44:45], v3 offset:9216
    ds_read_b64_tr_b16 v[46:47], v3 offset:9984
    ds_read_b128 v[60:63], v72 offset:40960
    s_barrier
    s_waitcnt lgkmcnt(6)
    v_mfma_f32_32x32x16_bf16 v[16:31], v[36:39], v[52:55], v[16:31]
    ds_read_b64_tr_b16 v[32:33], v3 offset:12288
    ds_read_b64_tr_b16 v[34:35], v3 offset:13056
    ds_read_b128 v[48:51], v69 offset:49152
    s_waitcnt lgkmcnt(6)
    v_mfma_f32_32x32x16_bf16 v[16:31], v[40:43], v[56:59], v[16:31]
    ds_read_b64_tr_b16 v[36:37], v3 offset:15360
    ds_read_b64_tr_b16 v[38:39], v3 offset:16128
    ds_read_b128 v[52:55], v70 offset:49152
    s_waitcnt lgkmcnt(6)
    v_mfma_f32_32x32x16_bf16 v[16:31], v[44:47], v[60:63], v[16:31]
    ds_read_b64_tr_b16 v[40:41], v3 offset:18432
    ds_read_b64_tr_b16 v[42:43], v3 offset:19200
    ds_read_b128 v[56:59], v71 offset:49152
    s_waitcnt lgkmcnt(6)
    v_mfma_f32_32x32x16_bf16 v[16:31], v[32:35], v[48:51], v[16:31]
    ds_read_b64_tr_b16 v[44:45], v3 offset:21504
    ds_read_b64_tr_b16 v[46:47], v3 offset:22272
    ds_read_b128 v[60:63], v72 offset:49152
    s_barrier
    s_waitcnt lgkmcnt(6)
    v_mfma_f32_32x32x16_bf16 v[16:31], v[36:39], v[52:55], v[16:31]
    ds_read_b64_tr_b16 v[32:33], v3 offset:24576
    ds_read_b64_tr_b16 v[34:35], v3 offset:25344
    ds_read_b128 v[48:51], v69 offset:57344
    s_waitcnt lgkmcnt(6)
    v_mfma_f32_32x32x16_bf16 v[16:31], v[40:43], v[56:59], v[16:31]
    ds_read_b64_tr_b16 v[36:37], v3 offset:27648
    ds_read_b64_tr_b16 v[38:39], v3 offset:28416
    ds_read_b128 v[52:55], v70 offset:57344
    s_waitcnt lgkmcnt(6)
    v_mfma_f32_32x32x16_bf16 v[16:31], v[44:47], v[60:63], v[16:31]
    ds_read_b64_tr_b16 v[40:41], v3 offset:30720
    ds_read_b64_tr_b16 v[42:43], v3 offset:31488
    ds_read_b128 v[56:59], v71 offset:57344
    s_waitcnt lgkmcnt(6)
    v_mfma_f32_32x32x16_bf16 v[16:31], v[32:35], v[48:51], v[16:31]
    ds_read_b64_tr_b16 v[44:45], v3 offset:33792
    ds_read_b64_tr_b16 v[46:47], v3 offset:34560
    ds_read_b128 v[60:63], v72 offset:57344
    s_barrier
    s_waitcnt lgkmcnt(6)
    v_mfma_f32_32x32x16_bf16 v[16:31], v[36:39], v[52:55], v[16:31]
    ds_read_b64_tr_b16 v[32:33], v2 offset:0
    ds_read_b64_tr_b16 v[34:35], v2 offset:768
    ds_read_b128 v[48:51], v69 offset:0
    s_waitcnt lgkmcnt(6)
    v_mfma_f32_32x32x16_bf16 v[16:31], v[40:43], v[56:59], v[16:31]
    ds_read_b64_tr_b16 v[36:37], v2 offset:3072
    ds_read_b64_tr_b16 v[38:39], v2 offset:3840
    ds_read_b128 v[52:55], v70 offset:0
    s_waitcnt lgkmcnt(6)
    v_mfma_f32_32x32x16_bf16 v[16:31], v[44:47], v[60:63], v[16:31]
    ds_read_b64_tr_b16 v[40:41], v2 offset:6144
    ds_read_b64_tr_b16 v[42:43], v2 offset:6912
    ds_read_b128 v[56:59], v71 offset:0
    s_waitcnt lgkmcnt(6)
    v_mfma_f32_32x32x16_bf16 v[16:31], v[32:35], v[48:51], v[16:31]
    ds_read_b64_tr_b16 v[44:45], v2 offset:9216
    ds_read_b64_tr_b16 v[46:47], v2 offset:9984
    ds_read_b128 v[60:63], v72 offset:0
    s_waitcnt lgkmcnt(6)
    v_mfma_f32_32x32x16_bf16 v[16:31], v[36:39], v[52:55], v[16:31]
    s_waitcnt lgkmcnt(3)
    v_mfma_f32_32x32x16_bf16 v[16:31], v[40:43], v[56:59], v[16:31]
    s_waitcnt lgkmcnt(0)
    v_mfma_f32_32x32x16_bf16 v[16:31], v[44:47], v[60:63], v[16:31]
    s_barrier
    s_mov_b32 s28, 0x3eae1a93
    s_nop 12
    v_cvt_pk_bf16_f32 v32, v16, v17
    v_cvt_pk_bf16_f32 v33, v18, v19
    v_cvt_pk_bf16_f32 v34, v20, v21
    v_cvt_pk_bf16_f32 v35, v22, v23
    v_cvt_pk_bf16_f32 v36, v24, v25
    v_cvt_pk_bf16_f32 v37, v26, v27
    v_cvt_pk_bf16_f32 v38, v28, v29
    v_cvt_pk_bf16_f32 v39, v30, v31
    v_lshlrev_b32 v16, 16, v32
    v_and_b32 v17, 0xffff0000, v32
    v_mul_f32 v16, s28, v16
    v_mul_f32 v17, s28, v17
    v_cvt_pk_bf16_f32 v32, v16, v17
    v_lshlrev_b32 v18, 16, v33
    v_and_b32 v19, 0xffff0000, v33
    v_mul_f32 v18, s28, v18
    v_mul_f32 v19, s28, v19
    v_cvt_pk_bf16_f32 v33, v18, v19
    v_lshlrev_b32 v20, 16, v34
    v_and_b32 v21, 0xffff0000, v34
    v_mul_f32 v20, s28, v20
    v_mul_f32 v21, s28, v21
    v_cvt_pk_bf16_f32 v34, v20, v21
    v_lshlrev_b32 v22, 16, v35
    v_and_b32 v23, 0xffff0000, v35
    v_mul_f32 v22, s28, v22
    v_mul_f32 v23, s28, v23
    v_cvt_pk_bf16_f32 v35, v22, v23
    v_lshlrev_b32 v24, 16, v36
    v_and_b32 v25, 0xffff0000, v36
    v_mul_f32 v24, s28, v24
    v_mul_f32 v25, s28, v25
    v_cvt_pk_bf16_f32 v36, v24, v25
    v_lshlrev_b32 v26, 16, v37
    v_and_b32 v27, 0xffff0000, v37
    v_mul_f32 v26, s28, v26
    v_mul_f32 v27, s28, v27
    v_cvt_pk_bf16_f32 v37, v26, v27
    v_lshlrev_b32 v28, 16, v38
    v_and_b32 v29, 0xffff0000, v38
    v_mul_f32 v28, s28, v28
    v_mul_f32 v29, s28, v29
    v_cvt_pk_bf16_f32 v38, v28, v29
    v_lshlrev_b32 v30, 16, v39
    v_and_b32 v31, 0xffff0000, v39
    v_mul_f32 v30, s28, v30
    v_mul_f32 v31, s28, v31
    v_cvt_pk_bf16_f32 v39, v30, v31
    s_nop 1
    v_permlane32_swap_b32 v32, v34
    v_permlane32_swap_b32 v33, v35
    v_permlane32_swap_b32 v36, v38
    v_permlane32_swap_b32 v37, v39
    ds_write_b128 v77, v[32:35] offset:0
    ds_write_b128 v77, v[36:39] offset:32
    s_waitcnt lgkmcnt(0)
    s_branch L_pq_fin
L_pq_fin:
    s_barrier
    s_mov_b32 s28, 357913942
    s_lshl_b32 s35, s25, 2
    v_mov_b32 v10, 0x7fffff00
    v_add_u32 v6, 0, v0
    v_mul_hi_u32 v7, v6, s28
    v_mul_u32_u24 v8, 12, v7
    v_sub_u32 v8, v6, v8
    v_cmp_gt_u32 vcc, s35, v8
    v_mul_u32_u24 v9, 208, v7
    v_lshl_add_u32 v9, v8, 4, v9
    ds_read_b128 v[16:19], v9
    v_mul_lo_u32 v7, v7, s24
    v_lshl_add_u32 v7, v8, 4, v7
    v_cndmask_b32 v24, v10, v7, vcc
    v_add_u32 v6, 384, v0
    v_mul_hi_u32 v7, v6, s28
    v_mul_u32_u24 v8, 12, v7
    v_sub_u32 v8, v6, v8
    v_cmp_gt_u32 vcc, s35, v8
    v_mul_u32_u24 v9, 208, v7
    v_lshl_add_u32 v9, v8, 4, v9
    ds_read_b128 v[20:23], v9
    v_mul_lo_u32 v7, v7, s24
    v_lshl_add_u32 v7, v8, 4, v7
    v_cndmask_b32 v25, v10, v7, vcc
    s_waitcnt lgkmcnt(1)
    buffer_store_dwordx4 v[16:19], v24, s[16:19], s23 offen
    s_waitcnt lgkmcnt(0)
    buffer_store_dwordx4 v[20:23], v25, s[16:19], s23 offen
L_pb_end:
    s_endpgm
L_pb_KV:
    s_cmp_ge_u32 s27, 4
    s_cbranch_scc1 L_kv_w4
    s_cmp_ge_u32 s27, 2
    s_cbranch_scc1 L_kv_donly
    v_and_b32 v1, 63, v0
    s_lshl_b32 s29, s27, 3
    v_lshrrev_b32 v6, 3, v1
    v_add_u32 v6, s29, v6
    v_mul_u32_u24 v6, 1152, v6
    v_lshrrev_b32 v7, 4, v1
    s_lshl_b32 s29, s27, 2
    v_add_u32 v7, s29, v7
    v_and_b32 v7, 7, v7
    v_and_b32 v8, 7, v1
    v_xor_b32 v7, v7, v8
    v_lshl_add_u32 v96, v7, 4, v6
    v_add_u32 v97, 36864, v96
    s_lshl_b32 s33, s27, 10
    s_add_u32 s33, s33, 111616
    s_waitcnt lgkmcnt(0)
    s_mov_b32 s8, s46
    s_mov_b32 s9, s47
    s_mov_b32 s10, 2359296
    s_mov_b32 s11, 0x00020000
    s_mov_b32 s12, s50
    s_mov_b32 s13, s51
    s_mov_b32 s14, 20736
    s_mov_b32 s15, 0x00020000
    s_mov_b32 s36, s52
    s_mov_b32 s37, s53
    s_mov_b32 s38, 20736
    s_mov_b32 s39, 0x00020000
    s_mov_b32 s16, s56
    s_mov_b32 s17, s57
    s_mov_b32 s18, 16777216
    s_mov_b32 s19, 0x00020000
    v_lshlrev_b32 v9, 2, v0
    s_mov_b32 s28, 0
    buffer_load_dword v107, v9, s[12:15], s28 offen
    buffer_load_dword v128, v9, s[36:39], s28 offen
    s_mov_b32 s28, 1024
    buffer_load_dword v108, v9, s[12:15], s28 offen
    buffer_load_dword v129, v9, s[36:39], s28 offen
    s_mov_b32 s28, 2048
    buffer_load_dword v109, v9, s[12:15], s28 offen
    buffer_load_dword v130, v9, s[36:39], s28 offen
    s_mov_b32 s28, 3072
    buffer_load_dword v110, v9, s[12:15], s28 offen
    buffer_load_dword v131, v9, s[36:39], s28 offen
    s_mov_b32 s28, 4096
    buffer_load_dword v111, v9, s[12:15], s28 offen
    buffer_load_dword v132, v9, s[36:39], s28 offen
    s_mov_b32 s28, 5120
    buffer_load_dword v112, v9, s[12:15], s28 offen
    buffer_load_dword v133, v9, s[36:39], s28 offen
    s_mov_b32 s28, 6144
    buffer_load_dword v113, v9, s[12:15], s28 offen
    buffer_load_dword v134, v9, s[36:39], s28 offen
    s_mov_b32 s28, 7168
    buffer_load_dword v114, v9, s[12:15], s28 offen
    buffer_load_dword v135, v9, s[36:39], s28 offen
    s_mov_b32 s28, 8192
    buffer_load_dword v115, v9, s[12:15], s28 offen
    buffer_load_dword v136, v9, s[36:39], s28 offen
    s_mov_b32 s28, 9216
    buffer_load_dword v116, v9, s[12:15], s28 offen
    buffer_load_dword v137, v9, s[36:39], s28 offen
    s_mov_b32 s28, 10240
    buffer_load_dword v117, v9, s[12:15], s28 offen
    buffer_load_dword v138, v9, s[36:39], s28 offen
    s_mov_b32 s28, 11264
    buffer_load_dword v118, v9, s[12:15], s28 offen
    buffer_load_dword v139, v9, s[36:39], s28 offen
    s_mov_b32 s28, 12288
    buffer_load_dword v119, v9, s[12:15], s28 offen
    buffer_load_dword v140, v9, s[36:39], s28 offen
    s_mov_b32 s28, 13312
    buffer_load_dword v120, v9, s[12:15], s28 offen
    buffer_load_dword v141, v9, s[36:39], s28 offen
    s_mov_b32 s28, 14336
    buffer_load_dword v121, v9, s[12:15], s28 offen
    buffer_load_dword v142, v9, s[36:39], s28 offen
    s_mov_b32 s28, 15360
    buffer_load_dword v122, v9, s[12:15], s28 offen
    buffer_load_dword v143, v9, s[36:39], s28 offen
    s_mov_b32 s28, 16384
    buffer_load_dword v123, v9, s[12:15], s28 offen
    buffer_load_dword v144, v9, s[36:39], s28 offen
    s_mov_b32 s28, 17408
    buffer_load_dword v124, v9, s[12:15], s28 offen
    buffer_load_dword v145, v9, s[36:39], s28 offen
    s_mov_b32 s28, 18432
    buffer_load_dword v125, v9, s[12:15], s28 offen
    buffer_load_dword v146, v9, s[36:39], s28 offen
    s_mov_b32 s28, 19456
    buffer_load_dword v126, v9, s[12:15], s28 offen
    buffer_load_dword v147, v9, s[36:39], s28 offen
    s_mov_b32 s28, 20480
    buffer_load_dword v127, v9, s[12:15], s28 offen
    buffer_load_dword v148, v9, s[36:39], s28 offen
    s_add_u32 m0, s33, 0
    s_nop 0
    buffer_load_dwordx4 v96, s[8:11], s20 offen lds
    s_add_u32 m0, s33, 4096
    s_nop 0
    buffer_load_dwordx4 v97, s[8:11], s20 offen lds
    s_add_u32 s20, s20, 128
    s_add_u32 m0, s33, 8192
    s_nop 0
    buffer_load_dwordx4 v96, s[8:11], s20 offen lds
    s_add_u32 m0, s33, 12288
    s_nop 0
    buffer_load_dwordx4 v97, s[8:11], s20 offen lds
    s_add_u32 s20, s20, 128
    s_add_u32 m0, s33, 16384
    s_nop 0
    buffer_load_dwordx4 v96, s[8:11], s20 offen lds
    s_add_u32 m0, s33, 20480
    s_nop 0
    buffer_load_dwordx4 v97, s[8:11], s20 offen lds
    s_add_u32 s20, s20, 128
    s_add_u32 m0, s33, 24576
    s_nop 0
    buffer_load_dwordx4 v96, s[8:11], s20 offen lds
    s_add_u32 m0, s33, 28672
    s_nop 0
    buffer_load_dwordx4 v97, s[8:11], s20 offen lds
    s_add_u32 s20, s20, 128
    s_add_u32 m0, s33, 32768
    s_nop 0
    buffer_load_dwordx4 v96, s[8:11], s20 offen lds
    s_add_u32 m0, s33, 36864
    s_nop 0
    buffer_load_dwordx4 v97, s[8:11], s20 offen lds
    s_add_u32 s20, s20, 128
    s_add_u32 m0, s33, 40960
    s_nop 0
    buffer_load_dwordx4 v96, s[8:11], s20 offen lds
    s_add_u32 m0, s33, 45056
    s_nop 0
    buffer_load_dwordx4 v97, s[8:11], s20 offen lds
    s_add_u32 s20, s20, 128
    s_mov_b32 s28, 477218589
    s_waitcnt vmcnt(12)
    v_add_u32 v6, 0, v0
    v_mul_hi_u32 v7, v6, s28
    v_mul_u32_u24 v8, 9, v7
    v_sub_u32 v8, v6, v8
    v_mul_u32_u24 v7, 192, v7
    v_lshl_add_u32 v7, v8, 2, v7
    ds_write_b32 v7, v107
    ds_write_b32 v7, v128 offset:64
    v_add_u32 v6, 256, v0
    v_mul_hi_u32 v7, v6, s28
    v_mul_u32_u24 v8, 9, v7
    v_sub_u32 v8, v6, v8
    v_mul_u32_u24 v7, 192, v7
    v_lshl_add_u32 v7, v8, 2, v7
    ds_write_b32 v7, v108
    ds_write_b32 v7, v129 offset:64
    v_add_u32 v6, 512, v0
    v_mul_hi_u32 v7, v6, s28
    v_mul_u32_u24 v8, 9, v7
    v_sub_u32 v8, v6, v8
    v_mul_u32_u24 v7, 192, v7
    v_lshl_add_u32 v7, v8, 2, v7
    ds_write_b32 v7, v109
    ds_write_b32 v7, v130 offset:64
    v_add_u32 v6, 768, v0
    v_mul_hi_u32 v7, v6, s28
    v_mul_u32_u24 v8, 9, v7
    v_sub_u32 v8, v6, v8
    v_mul_u32_u24 v7, 192, v7
    v_lshl_add_u32 v7, v8, 2, v7
    ds_write_b32 v7, v110
    ds_write_b32 v7, v131 offset:64
    v_add_u32 v6, 1024, v0
    v_mul_hi_u32 v7, v6, s28
    v_mul_u32_u24 v8, 9, v7
    v_sub_u32 v8, v6, v8
    v_mul_u32_u24 v7, 192, v7
    v_lshl_add_u32 v7, v8, 2, v7
    ds_write_b32 v7, v111
    ds_write_b32 v7, v132 offset:64
    v_add_u32 v6, 1280, v0
    v_mul_hi_u32 v7, v6, s28
    v_mul_u32_u24 v8, 9, v7
    v_sub_u32 v8, v6, v8
    v_mul_u32_u24 v7, 192, v7
    v_lshl_add_u32 v7, v8, 2, v7
    ds_write_b32 v7, v112
    ds_write_b32 v7, v133 offset:64
    v_add_u32 v6, 1536, v0
    v_mul_hi_u32 v7, v6, s28
    v_mul_u32_u24 v8, 9, v7
    v_sub_u32 v8, v6, v8
    v_mul_u32_u24 v7, 192, v7
    v_lshl_add_u32 v7, v8, 2, v7
    ds_write_b32 v7, v113
    ds_write_b32 v7, v134 offset:64
    v_add_u32 v6, 1792, v0
    v_mul_hi_u32 v7, v6, s28
    v_mul_u32_u24 v8, 9, v7
    v_sub_u32 v8, v6, v8
    v_mul_u32_u24 v7, 192, v7
    v_lshl_add_u32 v7, v8, 2, v7
    ds_write_b32 v7, v114
    ds_write_b32 v7, v135 offset:64
    v_add_u32 v6, 2048, v0
    v_mul_hi_u32 v7, v6, s28
    v_mul_u32_u24 v8, 9, v7
    v_sub_u32 v8, v6, v8
    v_mul_u32_u24 v7, 192, v7
    v_lshl_add_u32 v7, v8, 2, v7
    ds_write_b32 v7, v115
    ds_write_b32 v7, v136 offset:64
    v_add_u32 v6, 2304, v0
    v_mul_hi_u32 v7, v6, s28
    v_mul_u32_u24 v8, 9, v7
    v_sub_u32 v8, v6, v8
    v_mul_u32_u24 v7, 192, v7
    v_lshl_add_u32 v7, v8, 2, v7
    ds_write_b32 v7, v116
    ds_write_b32 v7, v137 offset:64
    v_add_u32 v6, 2560, v0
    v_mul_hi_u32 v7, v6, s28
    v_mul_u32_u24 v8, 9, v7
    v_sub_u32 v8, v6, v8
    v_mul_u32_u24 v7, 192, v7
    v_lshl_add_u32 v7, v8, 2, v7
    ds_write_b32 v7, v117
    ds_write_b32 v7, v138 offset:64
    v_add_u32 v6, 2816, v0
    v_mul_hi_u32 v7, v6, s28
    v_mul_u32_u24 v8, 9, v7
    v_sub_u32 v8, v6, v8
    v_mul_u32_u24 v7, 192, v7
    v_lshl_add_u32 v7, v8, 2, v7
    ds_write_b32 v7, v118
    ds_write_b32 v7, v139 offset:64
    v_add_u32 v6, 3072, v0
    v_mul_hi_u32 v7, v6, s28
    v_mul_u32_u24 v8, 9, v7
    v_sub_u32 v8, v6, v8
    v_mul_u32_u24 v7, 192, v7
    v_lshl_add_u32 v7, v8, 2, v7
    ds_write_b32 v7, v119
    ds_write_b32 v7, v140 offset:64
    v_add_u32 v6, 3328, v0
    v_mul_hi_u32 v7, v6, s28
    v_mul_u32_u24 v8, 9, v7
    v_sub_u32 v8, v6, v8
    v_mul_u32_u24 v7, 192, v7
    v_lshl_add_u32 v7, v8, 2, v7
    ds_write_b32 v7, v120
    ds_write_b32 v7, v141 offset:64
    v_add_u32 v6, 3584, v0
    v_mul_hi_u32 v7, v6, s28
    v_mul_u32_u24 v8, 9, v7
    v_sub_u32 v8, v6, v8
    v_mul_u32_u24 v7, 192, v7
    v_lshl_add_u32 v7, v8, 2, v7
    ds_write_b32 v7, v121
    ds_write_b32 v7, v142 offset:64
    v_add_u32 v6, 3840, v0
    v_mul_hi_u32 v7, v6, s28
    v_mul_u32_u24 v8, 9, v7
    v_sub_u32 v8, v6, v8
    v_mul_u32_u24 v7, 192, v7
    v_lshl_add_u32 v7, v8, 2, v7
    ds_write_b32 v7, v122
    ds_write_b32 v7, v143 offset:64
    v_add_u32 v6, 4096, v0
    v_mul_hi_u32 v7, v6, s28
    v_mul_u32_u24 v8, 9, v7
    v_sub_u32 v8, v6, v8
    v_mul_u32_u24 v7, 192, v7
    v_lshl_add_u32 v7, v8, 2, v7
    ds_write_b32 v7, v123
    ds_write_b32 v7, v144 offset:64
    v_add_u32 v6, 4352, v0
    v_mul_hi_u32 v7, v6, s28
    v_mul_u32_u24 v8, 9, v7
    v_sub_u32 v8, v6, v8
    v_mul_u32_u24 v7, 192, v7
    v_lshl_add_u32 v7, v8, 2, v7
    ds_write_b32 v7, v124
    ds_write_b32 v7, v145 offset:64
    v_add_u32 v6, 4608, v0
    v_mul_hi_u32 v7, v6, s28
    v_mul_u32_u24 v8, 9, v7
    v_sub_u32 v8, v6, v8
    v_mul_u32_u24 v7, 192, v7
    v_lshl_add_u32 v7, v8, 2, v7
    ds_write_b32 v7, v125
    ds_write_b32 v7, v146 offset:64
    v_add_u32 v6, 4864, v0
    v_mul_hi_u32 v7, v6, s28
    v_mul_u32_u24 v8, 9, v7
    v_sub_u32 v8, v6, v8
    v_mul_u32_u24 v7, 192, v7
    v_lshl_add_u32 v7, v8, 2, v7
    ds_write_b32 v7, v126
    ds_write_b32 v7, v147 offset:64
    v_add_u32 v6, 5120, v0
    v_mul_hi_u32 v7, v6, s28
    v_mul_u32_u24 v8, 9, v7
    v_sub_u32 v8, v6, v8
    v_mul_u32_u24 v7, 192, v7
    v_lshl_add_u32 v7, v8, 2, v7
    v_cmp_gt_u32 vcc, 64, v0
    s_and_saveexec_b64 s[34:35], vcc
    ds_write_b32 v7, v127
    ds_write_b32 v7, v148 offset:64
    s_mov_b64 exec, s[34:35]
    v_and_b32 v1, 63, v0
    s_and_b32 s34, s27, 1
    s_lshr_b32 s35, s27, 1
    v_lshrrev_b32 v6, 5, v1
    v_lshlrev_b32 v6, 3, v6
    v_bfe_u32 v7, v1, 2, 2
    v_add_u32 v6, v6, v7
    v_mul_u32_u24 v6, 192, v6
    v_bfe_u32 v7, v1, 4, 1
    v_lshlrev_b32 v7, 5, v7
    v_and_b32 v8, 3, v1
    v_lshlrev_b32 v8, 3, v8
    v_add3_u32 v2, v6, v7, v8
    s_mul_i32 s28, s35, 128
    v_add_u32 v2, s28, v2
    v_add_u32 v3, 61440, v2
    v_add_u32 v4, 122880, v2
    v_add_u32 v5, 184320, v2
    v_and_b32 v6, 31, v1
    v_lshrrev_b32 v7, 5, v1
    v_bfe_u32 v8, v1, 1, 3
    v_lshlrev_b32 v10, 7, v6
    s_mul_i32 s28, s34, 4096
    s_add_u32 s28, s28, 111616
    v_add_u32 v10, s28, v10
    v_add_u32 v9, 0, v7
    v_xor_b32 v9, v9, v8
    v_lshl_add_u32 v98, v9, 4, v10
    v_add_u32 v9, 2, v7
    v_xor_b32 v9, v9, v8
    v_lshl_add_u32 v99, v9, 4, v10
    v_add_u32 v9, 4, v7
    v_xor_b32 v9, v9, v8
    v_lshl_add_u32 v100, v9, 4, v10
    v_add_u32 v9, 6, v7
    v_xor_b32 v9, v9, v8
    v_lshl_add_u32 v101, v9, 4, v10
    s_mul_i32 s28, s34, 4608
    s_mul_i32 s29, s35, 128
    s_add_u32 s28, s28, s29
    v_mul_u32_u24 v6, 144, v6
    v_lshl_add_u32 v6, v7, 4, v6
    v_add_u32 v106, s28, v6
    s_waitcnt vmcnt(10) lgkmcnt(0)
    s_barrier
    ds_read_b64_tr_b16 v[48:49], v2 offset:0
    ds_read_b64_tr_b16 v[50:51], v2 offset:768
    ds_read_b64_tr_b16 v[52:53], v2 offset:64
    ds_read_b64_tr_b16 v[54:55], v2 offset:832
    ds_read_b128 v[80:83], v98 offset:0
    ds_read_b64_tr_b16 v[56:57], v2 offset:3072
    ds_read_b64_tr_b16 v[58:59], v2 offset:3840
    ds_read_b64_tr_b16 v[60:61], v2 offset:3136
    ds_read_b64_tr_b16 v[62:63], v2 offset:3904
    ds_read_b128 v[84:87], v99 offset:0
    ds_read_b64_tr_b16 v[64:65], v2 offset:6144
    ds_read_b64_tr_b16 v[66:67], v2 offset:6912
    ds_read_b64_tr_b16 v[68:69], v2 offset:6208
    ds_read_b64_tr_b16 v[70:71], v2 offset:6976
    ds_read_b128 v[88:91], v100 offset:0
    s_waitcnt lgkmcnt(10)
    v_mfma_f32_32x32x16_bf16 v[16:31], v[48:51], v[80:83], 0
    ds_read_b64_tr_b16 v[72:73], v2 offset:9216
    ds_read_b64_tr_b16 v[74:75], v2 offset:9984
    ds_read_b64_tr_b16 v[76:77], v2 offset:9280
    v_mfma_f32_32x32x16_bf16 v[32:47], v[80:83], v[52:55], 0
    ds_read_b64_tr_b16 v[78:79], v2 offset:10048
    ds_read_b128 v[92:95], v101 offset:0
    s_waitcnt vmcnt(8)
    s_barrier
    s_waitcnt lgkmcnt(10)
    v_mfma_f32_32x32x16_bf16 v[16:31], v[56:59], v[84:87], v[16:31]
    ds_read_b64_tr_b16 v[48:49], v2 offset:12288
    ds_read_b64_tr_b16 v[50:51], v2 offset:13056
    ds_read_b64_tr_b16 v[52:53], v2 offset:12352
    v_mfma_f32_32x32x16_bf16 v[32:47], v[84:87], v[60:63], v[32:47]
    ds_read_b64_tr_b16 v[54:55], v2 offset:13120
    ds_read_b128 v[80:83], v98 offset:8192
    s_waitcnt lgkmcnt(10)
    v_mfma_f32_32x32x16_bf16 v[16:31], v[64:67], v[88:91], v[16:31]
    ds_read_b64_tr_b16 v[56:57], v2 offset:15360
    ds_read_b64_tr_b16 v[58:59], v2 offset:16128
    ds_read_b64_tr_b16 v[60:61], v2 offset:15424
    v_mfma_f32_32x32x16_bf16 v[32:47], v[88:91], v[68:71], v[32:47]
    ds_read_b64_tr_b16 v[62:63], v2 offset:16192
    ds_read_b128 v[84:87], v99 offset:8192
    s_waitcnt lgkmcnt(10)
    v_mfma_f32_32x32x16_bf16 v[16:31], v[72:75], v[92:95], v[16:31]
    ds_read_b64_tr_b16 v[64:65], v2 offset:18432
    ds_read_b64_tr_b16 v[66:67], v2 offset:19200
    ds_read_b64_tr_b16 v[68:69], v2 offset:18496
    v_mfma_f32_32x32x16_bf16 v[32:47], v[92:95], v[76:79], v[32:47]
    ds_read_b64_tr_b16 v[70:71], v2 offset:19264
    ds_read_b128 v[88:91], v100 offset:8192
    s_waitcnt lgkmcnt(10)
    v_mfma_f32_32x32x16_bf16 v[16:31], v[48:51], v[80:83], v[16:31]
    ds_read_b64_tr_b16 v[72:73], v2 offset:21504
    ds_read_b64_tr_b16 v[74:75], v2 offset:22272
    ds_read_b64_tr_b16 v[76:77], v2 offset:21568
    v_mfma_f32_32x32x16_bf16 v[32:47], v[80:83], v[52:55], v[32:47]
    ds_read_b64_tr_b16 v[78:79], v2 offset:22336
    ds_read_b128 v[92:95], v101 offset:8192
    s_waitcnt vmcnt(6)
    s_barrier
    s_waitcnt lgkmcnt(10)
    v_mfma_f32_32x32x16_bf16 v[16:31], v[56:59], v[84:87], v[16:31]
    ds_read_b64_tr_b16 v[48:49], v2 offset:24576
    ds_read_b64_tr_b16 v[50:51], v2 offset:25344
    ds_read_b64_tr_b16 v[52:53], v2 offset:24640
    v_mfma_f32_32x32x16_bf16 v[32:47], v[84:87], v[60:63], v[32:47]
    ds_read_b64_tr_b16 v[54:55], v2 offset:25408
    ds_read_b128 v[80:83], v98 offset:16384
    s_add_u32 m0, s33, 0
    s_nop 0
    buffer_load_dwordx4 v96, s[8:11], s20 offen lds
    s_waitcnt lgkmcnt(10)
    v_mfma_f32_32x32x16_bf16 v[16:31], v[64:67], v[88:91], v[16:31]
    ds_read_b64_tr_b16 v[56:57], v2 offset:27648
    ds_read_b64_tr_b16 v[58:59], v2 offset:28416
    ds_read_b64_tr_b16 v[60:61], v2 offset:27712
    v_mfma_f32_32x32x16_bf16 v[32:47], v[88:91], v[68:71], v[32:47]
    ds_read_b64_tr_b16 v[62:63], v2 offset:28480
    ds_read_b128 v[84:87], v99 offset:16384
    s_add_u32 m0, s33, 4096
    s_nop 0
    buffer_load_dwordx4 v97, s[8:11], s20 offen lds
    s_add_u32 s20, s20, 128
    s_waitcnt lgkmcnt(10)
    v_mfma_f32_32x32x16_bf16 v[16:31], v[72:75], v[92:95], v[16:31]
    ds_read_b64_tr_b16 v[64:65], v2 offset:30720
    ds_read_b64_tr_b16 v[66:67], v2 offset:31488
    ds_read_b64_tr_b16 v[68:69], v2 offset:30784
    v_mfma_f32_32x32x16_bf16 v[32:47], v[92:95], v[76:79], v[32:47]
    ds_read_b64_tr_b16 v[70:71], v2 offset:31552
    ds_read_b128 v[88:91], v100 offset:16384
    s_waitcnt lgkmcnt(10)
    v_mfma_f32_32x32x16_bf16 v[16:31], v[48:51], v[80:83], v[16:31]
    ds_read_b64_tr_b16 v[72:73], v2 offset:33792
    ds_read_b64_tr_b16 v[74:75], v2 offset:34560
    ds_read_b64_tr_b16 v[76:77], v2 offset:33856
    v_mfma_f32_32x32x16_bf16 v[32:47], v[80:83], v[52:55], v[32:47]
    ds_read_b64_tr_b16 v[78:79], v2 offset:34624
    ds_read_b128 v[92:95], v101 offset:16384
    s_waitcnt vmcnt(6)
    s_barrier
    s_waitcnt lgkmcnt(10)
    v_mfma_f32_32x32x16_bf16 v[16:31], v[56:59], v[84:87], v[16:31]
    ds_read_b64_tr_b16 v[48:49], v2 offset:36864
    ds_read_b64_tr_b16 v[50:51], v2 offset:37632
    ds_read_b64_tr_b16 v[52:53], v2 offset:36928
    v_mfma_f32_32x32x16_bf16 v[32:47], v[84:87], v[60:63], v[32:47]
    ds_read_b64_tr_b16 v[54:55], v2 offset:37696
    ds_read_b128 v[80:83], v98 offset:24576
    s_add_u32 m0, s33, 8192
    s_nop 0
    buffer_load_dwordx4 v96, s[8:11], s20 offen lds
    s_waitcnt lgkmcnt(10)
    v_mfma_f32_32x32x16_bf16 v[16:31], v[64:67], v[88:91], v[16:31]
    ds_read_b64_tr_b16 v[56:57], v2 offset:39936
    ds_read_b64_tr_b16 v[58:59], v2 offset:40704
    ds_read_b64_tr_b16 v[60:61], v2 offset:40000
    v_mfma_f32_32x32x16_bf16 v[32:47], v[88:91], v[68:71], v[32:47]
    ds_read_b64_tr_b16 v[62:63], v2 offset:40768
    ds_read_b128 v[84:87], v99 offset:24576
    s_add_u32 m0, s33, 12288
    s_nop 0
    buffer_load_dwordx4 v97, s[8:11], s20 offen lds
    s_add_u32 s20, s20, 128
    s_waitcnt lgkmcnt(10)
    v_mfma_f32_32x32x16_bf16 v[16:31], v[72:75], v[92:95], v[16:31]
    ds_read_b64_tr_b16 v[64:65], v2 offset:43008
    ds_read_b64_tr_b16 v[66:67], v2 offset:43776
    ds_read_b64_tr_b16 v[68:69], v2 offset:43072
    v_mfma_f32_32x32x16_bf16 v[32:47], v[92:95], v[76:79], v[32:47]
    ds_read_b64_tr_b16 v[70:71], v2 offset:43840
    ds_read_b128 v[88:91], v100 offset:24576
    s_waitcnt lgkmcnt(10)
    v_mfma_f32_32x32x16_bf16 v[16:31], v[48:51], v[80:83], v[16:31]
    ds_read_b64_tr_b16 v[72:73], v2 offset:46080
    ds_read_b64_tr_b16 v[74:75], v2 offset:46848
    ds_read_b64_tr_b16 v[76:77], v2 offset:46144
    v_mfma_f32_32x32x16_bf16 v[32:47], v[80:83], v[52:55], v[32:47]
    ds_read_b64_tr_b16 v[78:79], v2 offset:46912
    ds_read_b128 v[92:95], v101 offset:24576
    s_waitcnt vmcnt(6)
    s_barrier
    s_waitcnt lgkmcnt(10)
    v_mfma_f32_32x32x16_bf16 v[16:31], v[56:59], v[84:87], v[16:31]
    ds_read_b64_tr_b16 v[48:49], v2 offset:49152
    ds_read_b64_tr_b16 v[50:51], v2 offset:49920
    ds_read_b64_tr_b16 v[52:53], v2 offset:49216
    v_mfma_f32_32x32x16_bf16 v[32:47], v[84:87], v[60:63], v[32:47]
    ds_read_b64_tr_b16 v[54:55], v2 offset:49984
    ds_read_b128 v[80:83], v98 offset:32768
    s_add_u32 m0, s33, 16384
    s_nop 0
    buffer_load_dwordx4 v96, s[8:11], s20 offen lds
    s_waitcnt lgkmcnt(10)
    v_mfma_f32_32x32x16_bf16 v[16:31], v[64:67], v[88:91], v[16:31]
    ds_read_b64_tr_b16 v[56:57], v2 offset:52224
    ds_read_b64_tr_b16 v[58:59], v2 offset:52992
    ds_read_b64_tr_b16 v[60:61], v2 offset:52288
    v_mfma_f32_32x32x16_bf16 v[32:47], v[88:91], v[68:71], v[32:47]
    ds_read_b64_tr_b16 v[62:63], v2 offset:53056
    ds_read_b128 v[84:87], v99 offset:32768
    s_add_u32 m0, s33, 20480
    s_nop 0
    buffer_load_dwordx4 v97, s[8:11], s20 offen lds
    s_add_u32 s20, s20, 128
    s_waitcnt lgkmcnt(10)
    v_mfma_f32_32x32x16_bf16 v[16:31], v[72:75], v[92:95], v[16:31]
    ds_read_b64_tr_b16 v[64:65], v2 offset:55296
    ds_read_b64_tr_b16 v[66:67], v2 offset:56064
    ds_read_b64_tr_b16 v[68:69], v2 offset:55360
    v_mfma_f32_32x32x16_bf16 v[32:47], v[92:95], v[76:79], v[32:47]
    ds_read_b64_tr_b16 v[70:71], v2 offset:56128
    ds_read_b128 v[88:91], v100 offset:32768
    s_waitcnt lgkmcnt(10)
    v_mfma_f32_32x32x16_bf16 v[16:31], v[48:51], v[80:83], v[16:31]
    ds_read_b64_tr_b16 v[72:73], v2 offset:58368
    ds_read_b64_tr_b16 v[74:75], v2 offset:59136
    ds_read_b64_tr_b16 v[76:77], v2 offset:58432
    v_mfma_f32_32x32x16_bf16 v[32:47], v[80:83], v[52:55], v[32:47]
    ds_read_b64_tr_b16 v[78:79], v2 offset:59200
    ds_read_b128 v[92:95], v101 offset:32768
    s_waitcnt vmcnt(6)
    s_barrier
    s_waitcnt lgkmcnt(10)
    v_mfma_f32_32x32x16_bf16 v[16:31], v[56:59], v[84:87], v[16:31]
    ds_read_b64_tr_b16 v[48:49], v3 offset:0
    ds_read_b64_tr_b16 v[50:51], v3 offset:768
    ds_read_b64_tr_b16 v[52:53], v3 offset:64
    v_mfma_f32_32x32x16_bf16 v[32:47], v[84:87], v[60:63], v[32:47]
    ds_read_b64_tr_b16 v[54:55], v3 offset:832
    ds_read_b128 v[80:83], v98 offset:40960
    s_waitcnt lgkmcnt(10)
    v_mfma_f32_32x32x16_bf16 v[16:31], v[64:67], v[88:91], v[16:31]
    ds_read_b64_tr_b16 v[56:57], v3 offset:3072
    ds_read_b64_tr_b16 v[58:59], v3 offset:3840
    ds_read_b64_tr_b16 v[60:61], v3 offset:3136
    v_mfma_f32_32x32x16_bf16 v[32:47], v[88:91], v[68:71], v[32:47]
    ds_read_b64_tr_b16 v[62:63], v3 offset:3904
    ds_read_b128 v[84:87], v99 offset:40960
    s_waitcnt lgkmcnt(10)
    v_mfma_f32_32x32x16_bf16 v[16:31], v[72:75], v[92:95], v[16:31]
    ds_read_b64_tr_b16 v[64:65], v3 offset:6144
    ds_read_b64_tr_b16 v[66:67], v3 offset:6912
    ds_read_b64_tr_b16 v[68:69], v3 offset:6208
    v_mfma_f32_32x32x16_bf16 v[32:47], v[92:95], v[76:79], v[32:47]
    ds_read_b64_tr_b16 v[70:71], v3 offset:6976
    ds_read_b128 v[88:91], v100 offset:40960
    s_waitcnt lgkmcnt(10)
    v_mfma_f32_32x32x16_bf16 v[16:31], v[48:51], v[80:83], v[16:31]
    ds_read_b64_tr_b16 v[72:73], v3 offset:9216
    ds_read_b64_tr_b16 v[74:75], v3 offset:9984
    ds_read_b64_tr_b16 v[76:77], v3 offset:9280
    v_mfma_f32_32x32x16_bf16 v[32:47], v[80:83], v[52:55], v[32:47]
    ds_read_b64_tr_b16 v[78:79], v3 offset:10048
    ds_read_b128 v[92:95], v101 offset:40960
    s_waitcnt vmcnt(4)
    s_barrier
    s_waitcnt lgkmcnt(10)
    v_mfma_f32_32x32x16_bf16 v[16:31], v[56:59], v[84:87], v[16:31]
    ds_read_b64_tr_b16 v[48:49], v3 offset:12288
    ds_read_b64_tr_b16 v[50:51], v3 offset:13056
    ds_read_b64_tr_b16 v[52:53], v3 offset:12352
    v_mfma_f32_32x32x16_bf16 v[32:47], v[84:87], v[60:63], v[32:47]
    ds_read_b64_tr_b16 v[54:55], v3 offset:13120
    ds_read_b128 v[80:83], v98 offset:0
    s_waitcnt lgkmcnt(10)
    v_mfma_f32_32x32x16_bf16 v[16:31], v[64:67], v[88:91], v[16:31]
    ds_read_b64_tr_b16 v[56:57], v3 offset:15360
    ds_read_b64_tr_b16 v[58:59], v3 offset:16128
    ds_read_b64_tr_b16 v[60:61], v3 offset:15424
    v_mfma_f32_32x32x16_bf16 v[32:47], v[88:91], v[68:71], v[32:47]
    ds_read_b64_tr_b16 v[62:63], v3 offset:16192
    ds_read_b128 v[84:87], v99 offset:0
    s_waitcnt lgkmcnt(10)
    v_mfma_f32_32x32x16_bf16 v[16:31], v[72:75], v[92:95], v[16:31]
    ds_read_b64_tr_b16 v[64:65], v3 offset:18432
    ds_read_b64_tr_b16 v[66:67], v3 offset:19200
    ds_read_b64_tr_b16 v[68:69], v3 offset:18496
    v_mfma_f32_32x32x16_bf16 v[32:47], v[92:95], v[76:79], v[32:47]
    ds_read_b64_tr_b16 v[70:71], v3 offset:19264
    ds_read_b128 v[88:91], v100 offset:0
    s_waitcnt lgkmcnt(10)
    v_mfma_f32_32x32x16_bf16 v[16:31], v[48:51], v[80:83], v[16:31]
    ds_read_b64_tr_b16 v[72:73], v3 offset:21504
    ds_read_b64_tr_b16 v[74:75], v3 offset:22272
    ds_read_b64_tr_b16 v[76:77], v3 offset:21568
    v_mfma_f32_32x32x16_bf16 v[32:47], v[80:83], v[52:55], v[32:47]
    ds_read_b64_tr_b16 v[78:79], v3 offset:22336
    ds_read_b128 v[92:95], v101 offset:0
    s_waitcnt vmcnt(2)
    s_barrier
    s_waitcnt lgkmcnt(10)
    v_mfma_f32_32x32x16_bf16 v[16:31], v[56:59], v[84:87], v[16:31]
    ds_read_b64_tr_b16 v[48:49], v3 offset:24576
    ds_read_b64_tr_b16 v[50:51], v3 offset:25344
    ds_read_b64_tr_b16 v[52:53], v3 offset:24640
    v_mfma_f32_32x32x16_bf16 v[32:47], v[84:87], v[60:63], v[32:47]
    ds_read_b64_tr_b16 v[54:55], v3 offset:25408
    ds_read_b128 v[80:83], v98 offset:8192
    s_waitcnt lgkmcnt(10)
    v_mfma_f32_32x32x16_bf16 v[16:31], v[64:67], v[88:91], v[16:31]
    ds_read_b64_tr_b16 v[56:57], v3 offset:27648
    ds_read_b64_tr_b16 v[58:59], v3 offset:28416
    ds_read_b64_tr_b16 v[60:61], v3 offset:27712
    v_mfma_f32_32x32x16_bf16 v[32:47], v[88:91], v[68:71], v[32:47]
    ds_read_b64_tr_b16 v[62:63], v3 offset:28480
    ds_read_b128 v[84:87], v99 offset:8192
    s_waitcnt lgkmcnt(10)
    v_mfma_f32_32x32x16_bf16 v[16:31], v[72:75], v[92:95], v[16:31]
    ds_read_b64_tr_b16 v[64:65], v3 offset:30720
    ds_read_b64_tr_b16 v[66:67], v3 offset:31488
    ds_read_b64_tr_b16 v[68:69], v3 offset:30784
    v_mfma_f32_32x32x16_bf16 v[32:47], v[92:95], v[76:79], v[32:47]
    ds_read_b64_tr_b16 v[70:71], v3 offset:31552
    ds_read_b128 v[88:91], v100 offset:8192
    s_waitcnt lgkmcnt(10)
    v_mfma_f32_32x32x16_bf16 v[16:31], v[48:51], v[80:83], v[16:31]
    ds_read_b64_tr_b16 v[72:73], v3 offset:33792
    ds_read_b64_tr_b16 v[74:75], v3 offset:34560
    ds_read_b64_tr_b16 v[76:77], v3 offset:33856
    v_mfma_f32_32x32x16_bf16 v[32:47], v[80:83], v[52:55], v[32:47]
    ds_read_b64_tr_b16 v[78:79], v3 offset:34624
    ds_read_b128 v[92:95], v101 offset:8192
    s_waitcnt vmcnt(0)
    s_barrier
    s_waitcnt lgkmcnt(10)
    v_mfma_f32_32x32x16_bf16 v[16:31], v[56:59], v[84:87], v[16:31]
    ds_read_b64_tr_b16 v[48:49], v3 offset:36864
    ds_read_b64_tr_b16 v[50:51], v3 offset:37632
    ds_read_b64_tr_b16 v[52:53], v3 offset:36928
    v_mfma_f32_32x32x16_bf16 v[32:47], v[84:87], v[60:63], v[32:47]
    ds_read_b64_tr_b16 v[54:55], v3 offset:37696
    ds_read_b128 v[80:83], v98 offset:16384
    s_waitcnt lgkmcnt(10)
    v_mfma_f32_32x32x16_bf16 v[16:31], v[64:67], v[88:91], v[16:31]
    ds_read_b64_tr_b16 v[56:57], v3 offset:39936
    ds_read_b64_tr_b16 v[58:59], v3 offset:40704
    ds_read_b64_tr_b16 v[60:61], v3 offset:40000
    v_mfma_f32_32x32x16_bf16 v[32:47], v[88:91], v[68:71], v[32:47]
    ds_read_b64_tr_b16 v[62:63], v3 offset:40768
    ds_read_b128 v[84:87], v99 offset:16384
    s_waitcnt lgkmcnt(10)
    v_mfma_f32_32x32x16_bf16 v[16:31], v[72:75], v[92:95], v[16:31]
    ds_read_b64_tr_b16 v[64:65], v3 offset:43008
    ds_read_b64_tr_b16 v[66:67], v3 offset:43776
    ds_read_b64_tr_b16 v[68:69], v3 offset:43072
    v_mfma_f32_32x32x16_bf16 v[32:47], v[92:95], v[76:79], v[32:47]
    ds_read_b64_tr_b16 v[70:71], v3 offset:43840
    ds_read_b128 v[88:91], v100 offset:16384
    s_waitcnt lgkmcnt(10)
    v_mfma_f32_32x32x16_bf16 v[16:31], v[48:51], v[80:83], v[16:31]
    ds_read_b64_tr_b16 v[72:73], v3 offset:46080
    ds_read_b64_tr_b16 v[74:75], v3 offset:46848
    ds_read_b64_tr_b16 v[76:77], v3 offset:46144
    v_mfma_f32_32x32x16_bf16 v[32:47], v[80:83], v[52:55], v[32:47]
    ds_read_b64_tr_b16 v[78:79], v3 offset:46912
    ds_read_b128 v[92:95], v101 offset:16384
    s_waitcnt lgkmcnt(10)
    v_mfma_f32_32x32x16_bf16 v[16:31], v[56:59], v[84:87], v[16:31]
    v_mfma_f32_32x32x16_bf16 v[32:47], v[84:87], v[60:63], v[32:47]
    s_waitcnt lgkmcnt(5)
    v_mfma_f32_32x32x16_bf16 v[16:31], v[64:67], v[88:91], v[16:31]
    v_mfma_f32_32x32x16_bf16 v[32:47], v[88:91], v[68:71], v[32:47]
    s_waitcnt lgkmcnt(0)
    v_mfma_f32_32x32x16_bf16 v[16:31], v[72:75], v[92:95], v[16:31]
    v_mfma_f32_32x32x16_bf16 v[32:47], v[92:95], v[76:79], v[32:47]
    s_barrier
    s_mul_i32 s28, s26, 2
    s_add_u32 s28, s28, s27
    s_mul_i32 s28, s28, 2432
    s_add_u32 s28, s28, 2359296
    v_and_b32 v6, 31, v1
    v_lshrrev_b32 v7, 5, v1
    v_lshlrev_b32 v8, 4, v6
    v_lshl_add_u32 v8, v7, 3, v8
    v_lshrrev_b32 v9, 3, v6
    v_mul_u32_u24 v9, 2432, v9
    v_and_b32 v10, 7, v6
    v_lshl_add_u32 v9, v10, 4, v9
    s_mul_i32 s29, s26, 2
    s_add_u32 s29, s29, s27
    s_and_b32 s29, s29, 3
    s_mul_i32 s29, s29, 2428
    s_sub_u32 s29, s28, s29
    v_mul_u32_u24 v10, 320, v7
    v_lshl_add_u32 v10, v6, 4, v10
    s_nop 4
    v_mul_f32 v32, 0x4f800000, v32
    v_mul_f32 v33, 0x4f800000, v33
    v_mul_f32 v34, 0x4f800000, v34
    v_mul_f32 v35, 0x4f800000, v35
    v_mul_f32 v36, 0x4f800000, v36
    v_mul_f32 v37, 0x4f800000, v37
    v_mul_f32 v38, 0x4f800000, v38
    v_mul_f32 v39, 0x4f800000, v39
    v_mul_f32 v40, 0x4f800000, v40
    v_mul_f32 v41, 0x4f800000, v41
    v_mul_f32 v42, 0x4f800000, v42
    v_mul_f32 v43, 0x4f800000, v43
    v_mul_f32 v44, 0x4f800000, v44
    v_mul_f32 v45, 0x4f800000, v45
    v_mul_f32 v46, 0x4f800000, v46
    v_mul_f32 v47, 0x4f800000, v47
    v_cvt_pk_bf16_f32 v48, v16, v17
    v_cvt_pk_bf16_f32 v49, v18, v19
    v_cvt_pk_bf16_f32 v50, v20, v21
    v_cvt_pk_bf16_f32 v51, v22, v23
    v_cvt_pk_bf16_f32 v52, v24, v25
    v_cvt_pk_bf16_f32 v53, v26, v27
    v_cvt_pk_bf16_f32 v54, v28, v29
    v_cvt_pk_bf16_f32 v55, v30, v31
    v_cvt_pk_bf16_f32 v56, v32, v33
    v_cvt_pk_bf16_f32 v57, v34, v35
    v_cvt_pk_bf16_f32 v58, v36, v37
    v_cvt_pk_bf16_f32 v59, v38, v39
    v_cvt_pk_bf16_f32 v60, v40, v41
    v_cvt_pk_bf16_f32 v61, v42, v43
    v_cvt_pk_bf16_f32 v62, v44, v45
    v_cvt_pk_bf16_f32 v63, v46, v47
    buffer_store_dwordx2 v[48:49], v8, s[16:19], s28 offen
    buffer_store_dwordx2 v[50:51], v8, s[16:19], s28 offen offset:512
    v_mov_b32 v11, 0x3f803f80
    v_cmp_eq_u32 vcc, 18, v6
    s_nop 1
    v_cndmask_b32 v56, v56, v11, vcc
    v_cndmask_b32 v57, v57, v11, vcc
    v_cndmask_b32 v58, v58, v11, vcc
    v_cndmask_b32 v59, v59, v11, vcc
    v_cndmask_b32 v60, v60, v11, vcc
    v_cndmask_b32 v61, v61, v11, vcc
    v_cndmask_b32 v62, v62, v11, vcc
    v_cndmask_b32 v63, v63, v11, vcc
    v_cmp_eq_u32 vcc, 19, v6
    s_nop 1
    v_cndmask_b32 v56, v56, 0, vcc
    v_cndmask_b32 v57, v57, 0, vcc
    v_cndmask_b32 v58, v58, 0, vcc
    v_cndmask_b32 v59, v59, 0, vcc
    v_cndmask_b32 v60, v60, 0, vcc
    v_cndmask_b32 v61, v61, 0, vcc
    v_cndmask_b32 v62, v62, 0, vcc
    v_cndmask_b32 v63, v63, 0, vcc
    v_cmp_gt_u32 vcc, 20, v6
    s_and_saveexec_b64 s[34:35], vcc
    buffer_store_dwordx4 v[56:59], v10, s[16:19], s28 offen offset:1152
    buffer_store_dwordx4 v[60:63], v10, s[16:19], s28 offen offset:1792
    s_mov_b64 exec, s[34:35]
    v_cmp_gt_u32 vcc, 32, v1
    s_and_saveexec_b64 s[34:35], vcc
    buffer_store_dword v52, v9, s[16:19], s29 offen offset:1024
    s_mov_b64 exec, s[34:35]
    s_branch L_kv_fin
L_kv_donly:
    v_and_b32 v1, 63, v0
    s_lshl_b32 s29, s27, 3
    v_lshrrev_b32 v6, 3, v1
    v_add_u32 v6, s29, v6
    v_mul_u32_u24 v6, 1152, v6
    v_lshrrev_b32 v7, 4, v1
    s_lshl_b32 s29, s27, 2
    v_add_u32 v7, s29, v7
    v_and_b32 v7, 7, v7
    v_and_b32 v8, 7, v1
    v_xor_b32 v7, v7, v8
    v_lshl_add_u32 v96, v7, 4, v6
    v_add_u32 v97, 36864, v96
    s_lshl_b32 s33, s27, 10
    s_add_u32 s33, s33, 111616
    s_waitcnt lgkmcnt(0)
    s_mov_b32 s8, s46
    s_mov_b32 s9, s47
    s_mov_b32 s10, 2359296
    s_mov_b32 s11, 0x00020000
    s_mov_b32 s12, s50
    s_mov_b32 s13, s51
    s_mov_b32 s14, 20736
    s_mov_b32 s15, 0x00020000
    s_mov_b32 s36, s52
    s_mov_b32 s37, s53
    s_mov_b32 s38, 20736
    s_mov_b32 s39, 0x00020000
    s_mov_b32 s16, s56
    s_mov_b32 s17, s57
    s_mov_b32 s18, 16777216
    s_mov_b32 s19, 0x00020000
    v_lshlrev_b32 v9, 2, v0
    s_mov_b32 s28, 0
    buffer_load_dword v107, v9, s[12:15], s28 offen
    buffer_load_dword v128, v9, s[36:39], s28 offen
    s_mov_b32 s28, 1024
    buffer_load_dword v108, v9, s[12:15], s28 offen
    buffer_load_dword v129, v9, s[36:39], s28 offen
    s_mov_b32 s28, 2048
    buffer_load_dword v109, v9, s[12:15], s28 offen
    buffer_load_dword v130, v9, s[36:39], s28 offen
    s_mov_b32 s28, 3072
    buffer_load_dword v110, v9, s[12:15], s28 offen
    buffer_load_dword v131, v9, s[36:39], s28 offen
    s_mov_b32 s28, 4096
    buffer_load_dword v111, v9, s[12:15], s28 offen
    buffer_load_dword v132, v9, s[36:39], s28 offen
    s_mov_b32 s28, 5120
    buffer_load_dword v112, v9, s[12:15], s28 offen
    buffer_load_dword v133, v9, s[36:39], s28 offen
    s_mov_b32 s28, 6144
    buffer_load_dword v113, v9, s[12:15], s28 offen
    buffer_load_dword v134, v9, s[36:39], s28 offen
    s_mov_b32 s28, 7168
    buffer_load_dword v114, v9, s[12:15], s28 offen
    buffer_load_dword v135, v9, s[36:39], s28 offen
    s_mov_b32 s28, 8192
    buffer_load_dword v115, v9, s[12:15], s28 offen
    buffer_load_dword v136, v9, s[36:39], s28 offen
    s_mov_b32 s28, 9216
    buffer_load_dword v116, v9, s[12:15], s28 offen
    buffer_load_dword v137, v9, s[36:39], s28 offen
    s_mov_b32 s28, 10240
    buffer_load_dword v117, v9, s[12:15], s28 offen
    buffer_load_dword v138, v9, s[36:39], s28 offen
    s_mov_b32 s28, 11264
    buffer_load_dword v118, v9, s[12:15], s28 offen
    buffer_load_dword v139, v9, s[36:39], s28 offen
    s_mov_b32 s28, 12288
    buffer_load_dword v119, v9, s[12:15], s28 offen
    buffer_load_dword v140, v9, s[36:39], s28 offen
    s_mov_b32 s28, 13312
    buffer_load_dword v120, v9, s[12:15], s28 offen
    buffer_load_dword v141, v9, s[36:39], s28 offen
    s_mov_b32 s28, 14336
    buffer_load_dword v121, v9, s[12:15], s28 offen
    buffer_load_dword v142, v9, s[36:39], s28 offen
    s_mov_b32 s28, 15360
    buffer_load_dword v122, v9, s[12:15], s28 offen
    buffer_load_dword v143, v9, s[36:39], s28 offen
    s_mov_b32 s28, 16384
    buffer_load_dword v123, v9, s[12:15], s28 offen
    buffer_load_dword v144, v9, s[36:39], s28 offen
    s_mov_b32 s28, 17408
    buffer_load_dword v124, v9, s[12:15], s28 offen
    buffer_load_dword v145, v9, s[36:39], s28 offen
    s_mov_b32 s28, 18432
    buffer_load_dword v125, v9, s[12:15], s28 offen
    buffer_load_dword v146, v9, s[36:39], s28 offen
    s_mov_b32 s28, 19456
    buffer_load_dword v126, v9, s[12:15], s28 offen
    buffer_load_dword v147, v9, s[36:39], s28 offen
    s_mov_b32 s28, 20480
    buffer_load_dword v127, v9, s[12:15], s28 offen
    buffer_load_dword v148, v9, s[36:39], s28 offen
    s_add_u32 m0, s33, 0
    s_nop 0
    buffer_load_dwordx4 v96, s[8:11], s20 offen lds
    s_add_u32 m0, s33, 4096
    s_nop 0
    buffer_load_dwordx4 v97, s[8:11], s20 offen lds
    s_add_u32 s20, s20, 128
    s_add_u32 m0, s33, 8192
    s_nop 0
    buffer_load_dwordx4 v96, s[8:11], s20 offen lds
    s_add_u32 m0, s33, 12288
    s_nop 0
    buffer_load_dwordx4 v97, s[8:11], s20 offen lds
    s_add_u32 s20, s20, 128
    s_add_u32 m0, s33, 16384
    s_nop 0
    buffer_load_dwordx4 v96, s[8:11], s20 offen lds
    s_add_u32 m0, s33, 20480
    s_nop 0
    buffer_load_dwordx4 v97, s[8:11], s20 offen lds
    s_add_u32 s20, s20, 128
    s_add_u32 m0, s33, 24576
    s_nop 0
    buffer_load_dwordx4 v96, s[8:11], s20 offen lds
    s_add_u32 m0, s33, 28672
    s_nop 0
    buffer_load_dwordx4 v97, s[8:11], s20 offen lds
    s_add_u32 s20, s20, 128
    s_add_u32 m0, s33, 32768
    s_nop 0
    buffer_load_dwordx4 v96, s[8:11], s20 offen lds
    s_add_u32 m0, s33, 36864
    s_nop 0
    buffer_load_dwordx4 v97, s[8:11], s20 offen lds
    s_add_u32 s20, s20, 128
    s_add_u32 m0, s33, 40960
    s_nop 0
    buffer_load_dwordx4 v96, s[8:11], s20 offen lds
    s_add_u32 m0, s33, 45056
    s_nop 0
    buffer_load_dwordx4 v97, s[8:11], s20 offen lds
    s_add_u32 s20, s20, 128
    s_mov_b32 s28, 477218589
    s_waitcnt vmcnt(12)
    v_add_u32 v6, 0, v0
    v_mul_hi_u32 v7, v6, s28
    v_mul_u32_u24 v8, 9, v7
    v_sub_u32 v8, v6, v8
    v_mul_u32_u24 v7, 192, v7
    v_lshl_add_u32 v7, v8, 2, v7
    ds_write_b32 v7, v107
    ds_write_b32 v7, v128 offset:64
    v_add_u32 v6, 256, v0
    v_mul_hi_u32 v7, v6, s28
    v_mul_u32_u24 v8, 9, v7
    v_sub_u32 v8, v6, v8
    v_mul_u32_u24 v7, 192, v7
    v_lshl_add_u32 v7, v8, 2, v7
    ds_write_b32 v7, v108
    ds_write_b32 v7, v129 offset:64
    v_add_u32 v6, 512, v0
    v_mul_hi_u32 v7, v6, s28
    v_mul_u32_u24 v8, 9, v7
    v_sub_u32 v8, v6, v8
    v_mul_u32_u24 v7, 192, v7
    v_lshl_add_u32 v7, v8, 2, v7
    ds_write_b32 v7, v109
    ds_write_b32 v7, v130 offset:64
    v_add_u32 v6, 768, v0
    v_mul_hi_u32 v7, v6, s28
    v_mul_u32_u24 v8, 9, v7
    v_sub_u32 v8, v6, v8
    v_mul_u32_u24 v7, 192, v7
    v_lshl_add_u32 v7, v8, 2, v7
    ds_write_b32 v7, v110
    ds_write_b32 v7, v131 offset:64
    v_add_u32 v6, 1024, v0
    v_mul_hi_u32 v7, v6, s28
    v_mul_u32_u24 v8, 9, v7
    v_sub_u32 v8, v6, v8
    v_mul_u32_u24 v7, 192, v7
    v_lshl_add_u32 v7, v8, 2, v7
    ds_write_b32 v7, v111
    ds_write_b32 v7, v132 offset:64
    v_add_u32 v6, 1280, v0
    v_mul_hi_u32 v7, v6, s28
    v_mul_u32_u24 v8, 9, v7
    v_sub_u32 v8, v6, v8
    v_mul_u32_u24 v7, 192, v7
    v_lshl_add_u32 v7, v8, 2, v7
    ds_write_b32 v7, v112
    ds_write_b32 v7, v133 offset:64
    v_add_u32 v6, 1536, v0
    v_mul_hi_u32 v7, v6, s28
    v_mul_u32_u24 v8, 9, v7
    v_sub_u32 v8, v6, v8
    v_mul_u32_u24 v7, 192, v7
    v_lshl_add_u32 v7, v8, 2, v7
    ds_write_b32 v7, v113
    ds_write_b32 v7, v134 offset:64
    v_add_u32 v6, 1792, v0
    v_mul_hi_u32 v7, v6, s28
    v_mul_u32_u24 v8, 9, v7
    v_sub_u32 v8, v6, v8
    v_mul_u32_u24 v7, 192, v7
    v_lshl_add_u32 v7, v8, 2, v7
    ds_write_b32 v7, v114
    ds_write_b32 v7, v135 offset:64
    v_add_u32 v6, 2048, v0
    v_mul_hi_u32 v7, v6, s28
    v_mul_u32_u24 v8, 9, v7
    v_sub_u32 v8, v6, v8
    v_mul_u32_u24 v7, 192, v7
    v_lshl_add_u32 v7, v8, 2, v7
    ds_write_b32 v7, v115
    ds_write_b32 v7, v136 offset:64
    v_add_u32 v6, 2304, v0
    v_mul_hi_u32 v7, v6, s28
    v_mul_u32_u24 v8, 9, v7
    v_sub_u32 v8, v6, v8
    v_mul_u32_u24 v7, 192, v7
    v_lshl_add_u32 v7, v8, 2, v7
    ds_write_b32 v7, v116
    ds_write_b32 v7, v137 offset:64
    v_add_u32 v6, 2560, v0
    v_mul_hi_u32 v7, v6, s28
    v_mul_u32_u24 v8, 9, v7
    v_sub_u32 v8, v6, v8
    v_mul_u32_u24 v7, 192, v7
    v_lshl_add_u32 v7, v8, 2, v7
    ds_write_b32 v7, v117
    ds_write_b32 v7, v138 offset:64
    v_add_u32 v6, 2816, v0
    v_mul_hi_u32 v7, v6, s28
    v_mul_u32_u24 v8, 9, v7
    v_sub_u32 v8, v6, v8
    v_mul_u32_u24 v7, 192, v7
    v_lshl_add_u32 v7, v8, 2, v7
    ds_write_b32 v7, v118
    ds_write_b32 v7, v139 offset:64
    v_add_u32 v6, 3072, v0
    v_mul_hi_u32 v7, v6, s28
    v_mul_u32_u24 v8, 9, v7
    v_sub_u32 v8, v6, v8
    v_mul_u32_u24 v7, 192, v7
    v_lshl_add_u32 v7, v8, 2, v7
    ds_write_b32 v7, v119
    ds_write_b32 v7, v140 offset:64
    v_add_u32 v6, 3328, v0
    v_mul_hi_u32 v7, v6, s28
    v_mul_u32_u24 v8, 9, v7
    v_sub_u32 v8, v6, v8
    v_mul_u32_u24 v7, 192, v7
    v_lshl_add_u32 v7, v8, 2, v7
    ds_write_b32 v7, v120
    ds_write_b32 v7, v141 offset:64
    v_add_u32 v6, 3584, v0
    v_mul_hi_u32 v7, v6, s28
    v_mul_u32_u24 v8, 9, v7
    v_sub_u32 v8, v6, v8
    v_mul_u32_u24 v7, 192, v7
    v_lshl_add_u32 v7, v8, 2, v7
    ds_write_b32 v7, v121
    ds_write_b32 v7, v142 offset:64
    v_add_u32 v6, 3840, v0
    v_mul_hi_u32 v7, v6, s28
    v_mul_u32_u24 v8, 9, v7
    v_sub_u32 v8, v6, v8
    v_mul_u32_u24 v7, 192, v7
    v_lshl_add_u32 v7, v8, 2, v7
    ds_write_b32 v7, v122
    ds_write_b32 v7, v143 offset:64
    v_add_u32 v6, 4096, v0
    v_mul_hi_u32 v7, v6, s28
    v_mul_u32_u24 v8, 9, v7
    v_sub_u32 v8, v6, v8
    v_mul_u32_u24 v7, 192, v7
    v_lshl_add_u32 v7, v8, 2, v7
    ds_write_b32 v7, v123
    ds_write_b32 v7, v144 offset:64
    v_add_u32 v6, 4352, v0
    v_mul_hi_u32 v7, v6, s28
    v_mul_u32_u24 v8, 9, v7
    v_sub_u32 v8, v6, v8
    v_mul_u32_u24 v7, 192, v7
    v_lshl_add_u32 v7, v8, 2, v7
    ds_write_b32 v7, v124
    ds_write_b32 v7, v145 offset:64
    v_add_u32 v6, 4608, v0
    v_mul_hi_u32 v7, v6, s28
    v_mul_u32_u24 v8, 9, v7
    v_sub_u32 v8, v6, v8
    v_mul_u32_u24 v7, 192, v7
    v_lshl_add_u32 v7, v8, 2, v7
    ds_write_b32 v7, v125
    ds_write_b32 v7, v146 offset:64
    v_add_u32 v6, 4864, v0
    v_mul_hi_u32 v7, v6, s28
    v_mul_u32_u24 v8, 9, v7
    v_sub_u32 v8, v6, v8
    v_mul_u32_u24 v7, 192, v7
    v_lshl_add_u32 v7, v8, 2, v7
    ds_write_b32 v7, v126
    ds_write_b32 v7, v147 offset:64
    v_add_u32 v6, 5120, v0
    v_mul_hi_u32 v7, v6, s28
    v_mul_u32_u24 v8, 9, v7
    v_sub_u32 v8, v6, v8
    v_mul_u32_u24 v7, 192, v7
    v_lshl_add_u32 v7, v8, 2, v7
    v_cmp_gt_u32 vcc, 64, v0
    s_and_saveexec_b64 s[34:35], vcc
    ds_write_b32 v7, v127
    ds_write_b32 v7, v148 offset:64
    s_mov_b64 exec, s[34:35]
    s_waitcnt vmcnt(10) lgkmcnt(0)
    s_barrier
    s_waitcnt vmcnt(8)
    s_barrier
    s_waitcnt vmcnt(6)
    s_barrier
    s_add_u32 m0, s33, 0
    s_nop 0
    buffer_load_dwordx4 v96, s[8:11], s20 offen lds
    s_add_u32 m0, s33, 4096
    s_nop 0
    buffer_load_dwordx4 v97, s[8:11], s20 offen lds
    s_add_u32 s20, s20, 128
    s_waitcnt vmcnt(6)
    s_barrier
    s_add_u32 m0, s33, 8192
    s_nop 0
    buffer_load_dwordx4 v96, s[8:11], s20 offen lds
    s_add_u32 m0, s33, 12288
    s_nop 0
    buffer_load_dwordx4 v97, s[8:11], s20 offen lds
    s_add_u32 s20, s20, 128
    s_waitcnt vmcnt(6)
    s_barrier
    s_add_u32 m0, s33, 16384
    s_nop 0
    buffer_load_dwordx4 v96, s[8:11], s20 offen lds
    s_add_u32 m0, s33, 20480
    s_nop 0
    buffer_load_dwordx4 v97, s[8:11], s20 offen lds
    s_add_u32 s20, s20, 128
    s_waitcnt vmcnt(6)
    s_barrier
    s_waitcnt vmcnt(4)
    s_barrier
    s_waitcnt vmcnt(2)
    s_barrier
    s_waitcnt vmcnt(0)
    s_barrier
    s_barrier
    s_branch L_kv_fin
L_kv_w4:
    s_waitcnt lgkmcnt(0)
    s_mov_b32 s8, s46
    s_mov_b32 s9, s47
    s_mov_b32 s10, 2359296
    s_mov_b32 s11, 0x00020000
    s_mov_b32 s12, s50
    s_mov_b32 s13, s51
    s_mov_b32 s14, 20736
    s_mov_b32 s15, 0x00020000
    s_mov_b32 s36, s52
    s_mov_b32 s37, s53
    s_mov_b32 s38, 20736
    s_mov_b32 s39, 0x00020000
    s_mov_b32 s16, s56
    s_mov_b32 s17, s57
    s_mov_b32 s18, 16777216
    s_mov_b32 s19, 0x00020000
L_kv_idle:
    s_barrier
    s_barrier
    s_barrier
    s_barrier
    s_barrier
    s_barrier
    s_barrier
    s_barrier
    s_barrier
    s_barrier
L_kv_fin:
    s_barrier
    s_endpgm

.globl main_kernel
.p2align 8
.type main_kernel,@function
main_kernel:
    s_cmp_ge_u32 s2, 256
    s_cbranch_scc1 L_k2_a
    s_load_dwordx2 s[4:5], s[0:1], 80
    s_load_dwordx2 s[40:41], s[0:1], 16
    s_load_dwordx2 s[44:45], s[0:1], 56
    v_and_b32 v119, 63, v0
    v_lshrrev_b32 v115, 6, v0
    s_nop 0
    v_readfirstlane_b32 s12, v115
    v_and_b32 v116, 31, v119
    v_lshrrev_b32 v117, 5, v119
    s_and_b32 s13, s2, 7
    s_lshl_b32 s13, s13, 8
    s_and_b32 s22, s2, 0xf8
    s_add_u32 s22, s22, s13
    s_add_u32 s13, s22, s12
    s_mul_i32 s16, s13, 1152
    v_mul_u32_u24 v118, 36, v116
    v_lshl_add_u32 v120, v117, 4, v118
    v_lshlrev_b32 v112, 4, v119
    s_mul_i32 s19, s12, 2432
    s_add_u32 s20, s19, 2359296
    s_mov_b32 s23, 0
    s_mov_b32 s10, 16777216
    s_mov_b32 s11, 0x00020000
    s_waitcnt lgkmcnt(0)
    s_mov_b32 s8, s4
    s_mov_b32 s9, s5
    s_add_u32 m0, s19, s23
    s_nop 0
    buffer_load_dwordx4 v112, s[8:11], s20 offen lds
    buffer_load_dwordx4 v112, s[8:11], s20 offen offset:1024 lds
    s_mov_b64 exec, 0xffffff
    buffer_load_dwordx4 v112, s[8:11], s20 offen offset:2048 lds
    s_mov_b64 exec, -1
    s_add_u32 s20, s20, 19456
    s_add_u32 s23, s23, 19456
    s_cmp_eq_u32 s23, 77824
    s_cselect_b32 s23, 0, s23
    buffer_load_dwordx4 v[4:7], v120, s[8:11], s16 offen
    buffer_load_dword v8, v118, s[8:11], s16 offen offset:32
    s_add_u32 m0, s19, s23
    s_nop 0
    buffer_load_dwordx4 v112, s[8:11], s20 offen lds
    buffer_load_dwordx4 v112, s[8:11], s20 offen offset:1024 lds
    s_mov_b64 exec, 0xffffff
    buffer_load_dwordx4 v112, s[8:11], s20 offen offset:2048 lds
    s_mov_b64 exec, -1
    s_add_u32 s20, s20, 19456
    s_add_u32 s23, s23, 19456
    s_cmp_eq_u32 s23, 77824
    s_cselect_b32 s23, 0, s23
    v_lshrrev_b32 v2, 3, v116
    v_mul_u32_u24 v2, 2432, v2
    v_and_b32 v3, 7, v116
    v_lshl_add_u32 v113, v3, 4, v2
    v_mov_b32 v127, v113
    v_mov_b32 v2, 416
    v_cmp_gt_u32 vcc, 32, v119
    s_nop 1
    v_cndmask_b32 v113, v2, v113, vcc
    v_min_u32 v2, 19, v116
    v_mul_u32_u24 v3, 320, v117
    v_lshl_add_u32 v114, v2, 4, v3
    v_mov_b32 v9, 0
    v_mov_b32 v10, 0
    s_mov_b32 s21, 0x42c00000
    v_mov_b32 v1, 0xff800000
    v_cmp_gt_u32 vcc, 32, v119
    s_nop 0
    s_waitcnt vmcnt(3)
    v_cndmask_b32 v8, 0, v8, vcc
    v_mov_b32 v11, v8
    s_barrier
    ds_read_b128 v[92:95], v113 offset:1024
    ds_read_b128 v[84:87], v112 offset:0
    ds_read_b128 v[88:91], v112 offset:2432
    s_waitcnt lgkmcnt(1)
    v_mfma_f32_32x32x16_bf16 v[28:43], v[84:87], v[4:7], 0
    v_mfma_f32_32x32x8_bf16 v[28:43], v[92:93], v[8:9], v[28:43]
    s_add_u32 m0, s19, s23
    s_nop 0
    buffer_load_dwordx4 v112, s[8:11], s20 offen lds
    buffer_load_dwordx4 v112, s[8:11], s20 offen offset:1024 lds
    s_mov_b64 exec, 0xffffff
    buffer_load_dwordx4 v112, s[8:11], s20 offen offset:2048 lds
    s_mov_b64 exec, -1
    s_add_u32 s20, s20, 19456
    s_add_u32 s23, s23, 19456
    s_cmp_eq_u32 s23, 77824
    s_cselect_b32 s23, 0, s23
    s_nop 3
    v_max3_f32 v1, v28, v29, v1
    v_max3_f32 v1, v30, v31, v1
    v_max3_f32 v1, v32, v33, v1
    v_max3_f32 v1, v34, v35, v1
    v_max3_f32 v1, v36, v37, v1
    v_max3_f32 v1, v38, v39, v1
    v_max3_f32 v1, v40, v41, v1
    v_max3_f32 v1, v42, v43, v1
    ds_read_b128 v[96:99], v114 offset:1152
    ds_read_b128 v[100:103], v114 offset:1792
    v_mov_b32 v115, v1
    s_nop 1
    v_permlane32_swap_b32 v1, v115
    s_nop 1
    v_max_f32 v1, v1, v115
    v_add_f32 v1, s21, v1
    v_sub_f32 v1, 0, v1
    v_cvt_pk_bf16_f32 v1, v1, 0
    v_cmp_gt_u32 vcc, 32, v119
    v_mov_b32 v68, 0
    v_mov_b32 v69, 0
    v_mov_b32 v70, 0
    v_mov_b32 v71, 0
    v_mov_b32 v72, 0
    v_mov_b32 v73, 0
    v_mov_b32 v74, 0
    v_mov_b32 v75, 0
    v_mov_b32 v76, 0
    v_mov_b32 v77, 0
    v_mov_b32 v78, 0
    v_mov_b32 v79, 0
    v_mov_b32 v80, 0
    v_mov_b32 v81, 0
    v_mov_b32 v82, 0
    v_mov_b32 v83, 0
    v_cndmask_b32 v8, v1, v8, vcc
    v_cndmask_b32 v10, v1, v10, vcc
    v_mov_b32 v64, 0
    v_mov_b32 v65, 0
    v_mov_b32 v66, 0
    v_mov_b32 v67, 0
    v_mov_b32 v108, 0
    v_mov_b32 v109, 0
    v_mov_b32 v110, 0
    v_mov_b32 v111, 0
    v_mov_b32 v115, v112
    v_mov_b32 v116, v113
    v_mov_b32 v117, v114
    v_add_u32 v124, 19456, v112
    v_add_u32 v125, 19456, v113
    v_add_u32 v126, 19456, v114
    v_mfma_f32_32x32x16_bf16 v[28:43], v[84:87], v[4:7], 0
    v_mfma_f32_32x32x8_bf16 v[28:43], v[92:93], v[8:9], v[28:43]
    s_mov_b32 s14, 0
    s_mov_b32 s15, 38912
    s_nop 8
L_attn_loop:
    s_cmp_le_u32 s14, 5
    s_cbranch_scc1 L_attn_sync
L_attn_loop2:
    s_waitcnt lgkmcnt(0)
    ds_read_b128 v[84:87], v115 offset:4864
    v_mfma_f32_32x32x16_bf16 v[68:83], v[108:111], v[64:67], v[68:83]
    ds_read_b128 v[104:107], v117 offset:3584
    ds_read_b128 v[108:111], v117 offset:4224
    v_exp_f32 v28, v28
    v_exp_f32 v29, v29
    v_exp_f32 v30, v30
    v_exp_f32 v31, v31
    v_mfma_f32_32x32x16_bf16 v[44:59], v[88:91], v[4:7], 0
    v_exp_f32 v32, v32
    v_exp_f32 v33, v33
    v_exp_f32 v34, v34
    v_exp_f32 v35, v35
    v_cvt_pk_bf16_f32 v60, v28, v29
    v_cvt_pk_bf16_f32 v61, v30, v31
    v_mfma_f32_32x32x8_bf16 v[44:59], v[92:93], v[10:11], v[44:59]
    v_cvt_pk_bf16_f32 v62, v32, v33
    v_cvt_pk_bf16_f32 v63, v34, v35
    v_exp_f32 v36, v36
    v_exp_f32 v37, v37
    v_exp_f32 v38, v38
    v_exp_f32 v39, v39
    v_mfma_f32_32x32x16_bf16 v[68:83], v[96:99], v[60:63], v[68:83]
    v_exp_f32 v40, v40
    v_exp_f32 v41, v41
    v_exp_f32 v42, v42
    v_exp_f32 v43, v43
    v_cvt_pk_bf16_f32 v64, v36, v37
    v_cvt_pk_bf16_f32 v65, v38, v39
    v_cvt_pk_bf16_f32 v66, v40, v41
    v_cvt_pk_bf16_f32 v67, v42, v43
    s_waitcnt lgkmcnt(0)
    ds_read_b128 v[88:91], v115 offset:7296
    v_mfma_f32_32x32x16_bf16 v[68:83], v[100:103], v[64:67], v[68:83]
    ds_read_b128 v[96:99], v117 offset:6016
    ds_read_b128 v[100:103], v117 offset:6656
    v_exp_f32 v44, v44
    v_exp_f32 v45, v45
    v_exp_f32 v46, v46
    v_exp_f32 v47, v47
    v_mfma_f32_32x32x16_bf16 v[28:43], v[84:87], v[4:7], 0
    v_exp_f32 v48, v48
    v_exp_f32 v49, v49
    v_exp_f32 v50, v50
    v_exp_f32 v51, v51
    v_cvt_pk_bf16_f32 v60, v44, v45
    v_cvt_pk_bf16_f32 v61, v46, v47
    v_mfma_f32_32x32x8_bf16 v[28:43], v[94:95], v[8:9], v[28:43]
    v_cvt_pk_bf16_f32 v62, v48, v49
    v_cvt_pk_bf16_f32 v63, v50, v51
    v_exp_f32 v52, v52
    v_exp_f32 v53, v53
    v_exp_f32 v54, v54
    v_exp_f32 v55, v55
    v_mfma_f32_32x32x16_bf16 v[68:83], v[104:107], v[60:63], v[68:83]
    v_exp_f32 v56, v56
    v_exp_f32 v57, v57
    v_exp_f32 v58, v58
    v_exp_f32 v59, v59
    v_cvt_pk_bf16_f32 v64, v52, v53
    v_cvt_pk_bf16_f32 v65, v54, v55
    v_cvt_pk_bf16_f32 v66, v56, v57
    v_cvt_pk_bf16_f32 v67, v58, v59
    s_waitcnt lgkmcnt(0)
    ds_read_b128 v[84:87], v115 offset:9728
    ds_read_b128 v[120:123], v116 offset:10752
    v_mfma_f32_32x32x16_bf16 v[68:83], v[108:111], v[64:67], v[68:83]
    ds_read_b128 v[104:107], v117 offset:8448
    ds_read_b128 v[108:111], v117 offset:9088
    v_exp_f32 v28, v28
    v_exp_f32 v29, v29
    v_exp_f32 v30, v30
    v_exp_f32 v31, v31
    v_mfma_f32_32x32x16_bf16 v[44:59], v[88:91], v[4:7], 0
    v_exp_f32 v32, v32
    v_exp_f32 v33, v33
    v_exp_f32 v34, v34
    v_exp_f32 v35, v35
    v_cvt_pk_bf16_f32 v60, v28, v29
    v_cvt_pk_bf16_f32 v61, v30, v31
    v_mfma_f32_32x32x8_bf16 v[44:59], v[94:95], v[10:11], v[44:59]
    v_cvt_pk_bf16_f32 v62, v32, v33
    v_cvt_pk_bf16_f32 v63, v34, v35
    v_exp_f32 v36, v36
    v_exp_f32 v37, v37
    v_exp_f32 v38, v38
    v_exp_f32 v39, v39
    v_mfma_f32_32x32x16_bf16 v[68:83], v[96:99], v[60:63], v[68:83]
    v_exp_f32 v40, v40
    v_exp_f32 v41, v41
    v_exp_f32 v42, v42
    v_exp_f32 v43, v43
    v_cvt_pk_bf16_f32 v64, v36, v37
    v_cvt_pk_bf16_f32 v65, v38, v39
    v_cvt_pk_bf16_f32 v66, v40, v41
    v_cvt_pk_bf16_f32 v67, v42, v43
    s_waitcnt lgkmcnt(0)
    ds_read_b128 v[88:91], v115 offset:12160
    v_mfma_f32_32x32x16_bf16 v[68:83], v[100:103], v[64:67], v[68:83]
    ds_read_b128 v[96:99], v117 offset:10880
    ds_read_b128 v[100:103], v117 offset:11520
    v_exp_f32 v44, v44
    v_exp_f32 v45, v45
    v_exp_f32 v46, v46
    v_exp_f32 v47, v47
    v_mfma_f32_32x32x16_bf16 v[28:43], v[84:87], v[4:7], 0
    v_exp_f32 v48, v48
    v_exp_f32 v49, v49
    v_exp_f32 v50, v50
    v_exp_f32 v51, v51
    v_cvt_pk_bf16_f32 v60, v44, v45
    v_cvt_pk_bf16_f32 v61, v46, v47
    v_mfma_f32_32x32x8_bf16 v[28:43], v[120:121], v[8:9], v[28:43]
    v_cvt_pk_bf16_f32 v62, v48, v49
    v_cvt_pk_bf16_f32 v63, v50, v51
    v_exp_f32 v52, v52
    v_exp_f32 v53, v53
    v_exp_f32 v54, v54
    v_exp_f32 v55, v55
    v_mfma_f32_32x32x16_bf16 v[68:83], v[104:107], v[60:63], v[68:83]
    v_exp_f32 v56, v56
    v_exp_f32 v57, v57
    v_exp_f32 v58, v58
    v_exp_f32 v59, v59
    v_cvt_pk_bf16_f32 v64, v52, v53
    v_cvt_pk_bf16_f32 v65, v54, v55
    v_cvt_pk_bf16_f32 v66, v56, v57
    v_cvt_pk_bf16_f32 v67, v58, v59
    s_waitcnt lgkmcnt(0)
    ds_read_b128 v[84:87], v115 offset:14592
    v_mfma_f32_32x32x16_bf16 v[68:83], v[108:111], v[64:67], v[68:83]
    ds_read_b128 v[104:107], v117 offset:13312
    ds_read_b128 v[108:111], v117 offset:13952
    v_exp_f32 v28, v28
    v_exp_f32 v29, v29
    v_exp_f32 v30, v30
    v_exp_f32 v31, v31
    v_mfma_f32_32x32x16_bf16 v[44:59], v[88:91], v[4:7], 0
    v_exp_f32 v32, v32
    v_exp_f32 v33, v33
    v_exp_f32 v34, v34
    v_exp_f32 v35, v35
    v_cvt_pk_bf16_f32 v60, v28, v29
    v_cvt_pk_bf16_f32 v61, v30, v31
    v_mfma_f32_32x32x8_bf16 v[44:59], v[120:121], v[10:11], v[44:59]
    v_cvt_pk_bf16_f32 v62, v32, v33
    v_cvt_pk_bf16_f32 v63, v34, v35
    v_exp_f32 v36, v36
    v_exp_f32 v37, v37
    v_exp_f32 v38, v38
    v_exp_f32 v39, v39
    v_mfma_f32_32x32x16_bf16 v[68:83], v[96:99], v[60:63], v[68:83]
    v_exp_f32 v40, v40
    v_exp_f32 v41, v41
    v_exp_f32 v42, v42
    v_exp_f32 v43, v43
    v_cvt_pk_bf16_f32 v64, v36, v37
    v_cvt_pk_bf16_f32 v65, v38, v39
    v_cvt_pk_bf16_f32 v66, v40, v41
    v_cvt_pk_bf16_f32 v67, v42, v43
    s_waitcnt lgkmcnt(0)
    ds_read_b128 v[88:91], v115 offset:17024
    v_mfma_f32_32x32x16_bf16 v[68:83], v[100:103], v[64:67], v[68:83]
    ds_read_b128 v[96:99], v117 offset:15744
    ds_read_b128 v[100:103], v117 offset:16384
    v_exp_f32 v44, v44
    v_exp_f32 v45, v45
    v_exp_f32 v46, v46
    v_exp_f32 v47, v47
    v_mfma_f32_32x32x16_bf16 v[28:43], v[84:87], v[4:7], 0
    v_exp_f32 v48, v48
    v_exp_f32 v49, v49
    v_exp_f32 v50, v50
    v_exp_f32 v51, v51
    v_cvt_pk_bf16_f32 v60, v44, v45
    v_cvt_pk_bf16_f32 v61, v46, v47
    v_mfma_f32_32x32x8_bf16 v[28:43], v[122:123], v[8:9], v[28:43]
    v_cvt_pk_bf16_f32 v62, v48, v49
    v_cvt_pk_bf16_f32 v63, v50, v51
    v_exp_f32 v52, v52
    v_exp_f32 v53, v53
    v_exp_f32 v54, v54
    v_exp_f32 v55, v55
    v_mfma_f32_32x32x16_bf16 v[68:83], v[104:107], v[60:63], v[68:83]
    v_exp_f32 v56, v56
    v_exp_f32 v57, v57
    v_exp_f32 v58, v58
    v_exp_f32 v59, v59
    v_cvt_pk_bf16_f32 v64, v52, v53
    v_cvt_pk_bf16_f32 v65, v54, v55
    v_cvt_pk_bf16_f32 v66, v56, v57
    v_cvt_pk_bf16_f32 v67, v58, v59
    s_waitcnt lgkmcnt(0)
    ds_read_b128 v[84:87], v124 offset:0
    ds_read_b128 v[92:95], v125 offset:1024
    v_mfma_f32_32x32x16_bf16 v[68:83], v[108:111], v[64:67], v[68:83]
    ds_read_b128 v[104:107], v117 offset:18176
    ds_read_b128 v[108:111], v117 offset:18816
    v_exp_f32 v28, v28
    v_exp_f32 v29, v29
    v_exp_f32 v30, v30
    v_exp_f32 v31, v31
    v_mfma_f32_32x32x16_bf16 v[44:59], v[88:91], v[4:7], 0
    v_exp_f32 v32, v32
    v_exp_f32 v33, v33
    v_exp_f32 v34, v34
    v_exp_f32 v35, v35
    v_cvt_pk_bf16_f32 v60, v28, v29
    v_cvt_pk_bf16_f32 v61, v30, v31
    v_mfma_f32_32x32x8_bf16 v[44:59], v[122:123], v[10:11], v[44:59]
    v_cvt_pk_bf16_f32 v62, v32, v33
    v_cvt_pk_bf16_f32 v63, v34, v35
    v_exp_f32 v36, v36
    v_exp_f32 v37, v37
    v_exp_f32 v38, v38
    v_exp_f32 v39, v39
    v_mfma_f32_32x32x16_bf16 v[68:83], v[96:99], v[60:63], v[68:83]
    v_exp_f32 v40, v40
    v_exp_f32 v41, v41
    v_exp_f32 v42, v42
    v_exp_f32 v43, v43
    v_cvt_pk_bf16_f32 v64, v36, v37
    v_cvt_pk_bf16_f32 v65, v38, v39
    v_cvt_pk_bf16_f32 v66, v40, v41
    v_cvt_pk_bf16_f32 v67, v42, v43
    s_waitcnt lgkmcnt(0)
    ds_read_b128 v[88:91], v124 offset:2432
    v_mfma_f32_32x32x16_bf16 v[68:83], v[100:103], v[64:67], v[68:83]
    ds_read_b128 v[96:99], v126 offset:1152
    ds_read_b128 v[100:103], v126 offset:1792
    v_exp_f32 v44, v44
    v_exp_f32 v45, v45
    v_exp_f32 v46, v46
    v_exp_f32 v47, v47
    v_mfma_f32_32x32x16_bf16 v[28:43], v[84:87], v[4:7], 0
    v_exp_f32 v48, v48
    v_exp_f32 v49, v49
    v_exp_f32 v50, v50
    v_exp_f32 v51, v51
    v_cvt_pk_bf16_f32 v60, v44, v45
    v_cvt_pk_bf16_f32 v61, v46, v47
    v_mfma_f32_32x32x8_bf16 v[28:43], v[92:93], v[8:9], v[28:43]
    v_cvt_pk_bf16_f32 v62, v48, v49
    v_cvt_pk_bf16_f32 v63, v50, v51
    v_exp_f32 v52, v52
    v_exp_f32 v53, v53
    v_exp_f32 v54, v54
    v_exp_f32 v55, v55
    v_mfma_f32_32x32x16_bf16 v[68:83], v[104:107], v[60:63], v[68:83]
    v_exp_f32 v56, v56
    v_exp_f32 v57, v57
    v_exp_f32 v58, v58
    v_exp_f32 v59, v59
    v_cvt_pk_bf16_f32 v64, v52, v53
    v_cvt_pk_bf16_f32 v65, v54, v55
    v_cvt_pk_bf16_f32 v66, v56, v57
    v_cvt_pk_bf16_f32 v67, v58, v59
    v_mov_b32 v115, v124
    v_mov_b32 v116, v125
    v_mov_b32 v117, v126
    v_add_u32 v124, s15, v112
    v_add_u32 v125, s15, v113
    v_add_u32 v126, s15, v114
    s_add_u32 s15, s15, 19456
    s_cmp_eq_u32 s15, 77824
    s_cselect_b32 s15, 0, s15
    s_add_u32 s14, s14, 1
    s_cmp_lt_u32 s14, 8
    s_cbranch_scc1 L_attn_loop
    v_mfma_f32_32x32x16_bf16 v[68:83], v[108:111], v[64:67], v[68:83]
    s_waitcnt lgkmcnt(0)
    s_nop 15
    v_mov_b32 v115, v78
    v_mov_b32 v116, v78
    s_nop 1
    v_permlane32_swap_b32 v115, v116
    s_nop 1
    v_mul_f32 v117, 0x4d800000, v115
    v_mul_f32 v117, 0, v117
    v_fmac_f32 v117, 0, v68
    v_fmac_f32 v117, 0, v69
    v_fmac_f32 v117, 0, v70
    v_fmac_f32 v117, 0, v71
    v_fmac_f32 v117, 0, v72
    v_fmac_f32 v117, 0, v73
    v_fmac_f32 v117, 0, v74
    v_fmac_f32 v117, 0, v75
    v_fmac_f32 v117, 0, v76
    v_fmac_f32 v117, 0, v77
    v_max3_f32 v2, |v68|, |v69|, |v70|
    v_max3_f32 v2, |v71|, |v72|, v2
    v_max3_f32 v2, |v73|, |v74|, v2
    v_max_f32 v2, |v75|, v2
    v_mov_b32 v3, v2
    v_cmp_u_f32 vcc, v117, v117
    s_nop 0
    v_permlane32_swap_b32 v2, v3
    s_mov_b64 s[24:25], vcc
    v_max_f32 v2, v2, v3
    v_min_f32 v2, v2, v115
    v_cmp_gt_f32 vcc, 0x0d800000, v2
    s_nop 1
    s_or_b64 vcc, vcc, s[24:25]
    s_cmp_lg_u64 vcc, 0
    s_cbranch_scc1 L_attn_slow
L_attn_ok:
    v_rcp_f32 v115, v115
    s_nop 0
    v_mul_f32 v68, v68, v115
    v_mul_f32 v69, v69, v115
    v_mul_f32 v70, v70, v115
    v_mul_f32 v71, v71, v115
    v_mul_f32 v72, v72, v115
    v_mul_f32 v73, v73, v115
    v_mul_f32 v74, v74, v115
    v_mul_f32 v75, v75, v115
    v_mul_f32 v76, v76, v115
    v_mul_f32 v77, v77, v115
    v_mul_f32 v68, 0x2f800000, v68
    v_mul_f32 v69, 0x2f800000, v69
    v_mul_f32 v70, 0x2f800000, v70
    v_mul_f32 v71, 0x2f800000, v71
    v_mul_f32 v72, 0x2f800000, v72
    v_mul_f32 v73, 0x2f800000, v73
    v_mul_f32 v74, 0x2f800000, v74
    v_mul_f32 v75, 0x2f800000, v75
    v_mul_f32 v76, 0x2f800000, v76
    v_mul_f32 v77, 0x2f800000, v77
    v_cvt_pk_bf16_f32 v60, v68, v69
    v_cvt_pk_bf16_f32 v61, v70, v71
    v_cvt_pk_bf16_f32 v62, v72, v73
    v_cvt_pk_bf16_f32 v63, v74, v75
    v_cvt_pk_bf16_f32 v64, v76, v77
    v_and_b32 v116, 31, v119
    v_lshrrev_b32 v117, 5, v119
    v_mul_u32_u24 v2, 36, v116
    v_lshl_add_u32 v2, v117, 3, v2
    s_add_u32 s16, s16, 2621440
    buffer_store_dwordx2 v[60:61], v2, s[8:11], s16 offen
    buffer_store_dwordx2 v[62:63], v2, s[8:11], s16 offen offset:16
    v_cmp_gt_u32 vcc, 32, v119
    s_and_b64 exec, exec, vcc
    buffer_store_dword v64, v2, s[8:11], s16 offen offset:32
    s_endpgm
L_attn_sync:
    s_cmp_eq_u32 s14, 5
    s_cbranch_scc1 L_attn_sync5
    s_waitcnt vmcnt(3)
    s_barrier
    s_add_u32 m0, s19, s23
    s_nop 0
    buffer_load_dwordx4 v112, s[8:11], s20 offen lds
    buffer_load_dwordx4 v112, s[8:11], s20 offen offset:1024 lds
    s_mov_b64 exec, 0xffffff
    buffer_load_dwordx4 v112, s[8:11], s20 offen offset:2048 lds
    s_mov_b64 exec, -1
    s_add_u32 s20, s20, 19456
    s_add_u32 s23, s23, 19456
    s_cmp_eq_u32 s23, 77824
    s_cselect_b32 s23, 0, s23
    s_branch L_attn_loop2
L_attn_sync5:
    s_waitcnt vmcnt(0)
    s_barrier
    s_mov_b32 s42, 663552
    s_mov_b32 s43, 0x00020000
    s_mov_b32 s46, 663552
    s_mov_b32 s47, 0x00020000
    s_and_b32 s24, s2, 0xf8
    s_add_u32 s24, s24, s12
    s_lshl_b32 s24, s24, 13
    v_lshlrev_b32 v2, 7, v119
    v_add_u32 v2, s24, v2
    v_subrev_u32 v3, 663552, v2
    buffer_load_dword v1, v2, s[40:43], 0 offen sc1
    buffer_load_dword v118, v3, s[44:47], 0 offen sc1
    s_branch L_attn_loop2
L_attn_slow:
    s_waitcnt vmcnt(0)
    s_mov_b32 s21, 0
    v_mov_b32 v1, 0xff800000
    v_mov_b32 v93, 0
    v_cmp_gt_u32 vcc, 32, v119
    v_mov_b32 v113, v127
    s_nop 0
    v_cndmask_b32 v8, 0, v8, vcc
    s_mov_b32 s20, 2359296
    s_mov_b32 s14, 0
L_attn_pre:
    s_and_b32 s24, s14, 3
    s_mul_i32 s24, s24, 2428
    s_sub_u32 s24, s20, s24
    buffer_load_dwordx4 v[84:87], v112, s[8:11], s20 offen
    buffer_load_dword v92, v113, s[8:11], s24 offen offset:1024
    s_add_u32 s20, s20, 2432
    s_waitcnt vmcnt(0)
    v_mfma_f32_32x32x16_bf16 v[28:43], v[84:87], v[4:7], 0
    v_mfma_f32_32x32x8_bf16 v[28:43], v[92:93], v[8:9], v[28:43]
    s_add_u32 s14, s14, 1
    s_nop 15
    v_max3_f32 v1, v28, v29, v1
    v_max3_f32 v1, v30, v31, v1
    v_max3_f32 v1, v32, v33, v1
    v_max3_f32 v1, v34, v35, v1
    v_max3_f32 v1, v36, v37, v1
    v_max3_f32 v1, v38, v39, v1
    v_max3_f32 v1, v40, v41, v1
    v_max3_f32 v1, v42, v43, v1
    s_cmp_lt_u32 s14, 64
    s_cbranch_scc1 L_attn_pre
    v_mov_b32 v115, v1
    s_nop 1
    v_permlane32_swap_b32 v1, v115
    s_nop 1
    v_max_f32 v1, v1, v115
    v_add_f32 v1, s21, v1
    v_sub_f32 v12, 0, v1
    v_sub_f32 v13, 0, v1
    v_sub_f32 v14, 0, v1
    v_sub_f32 v15, 0, v1
    v_sub_f32 v16, 0, v1
    v_sub_f32 v17, 0, v1
    v_sub_f32 v18, 0, v1
    v_sub_f32 v19, 0, v1
    v_sub_f32 v20, 0, v1
    v_sub_f32 v21, 0, v1
    v_sub_f32 v22, 0, v1
    v_sub_f32 v23, 0, v1
    v_sub_f32 v24, 0, v1
    v_sub_f32 v25, 0, v1
    v_sub_f32 v26, 0, v1
    v_sub_f32 v27, 0, v1
    v_mov_b32 v68, 0
    v_mov_b32 v69, 0
    v_mov_b32 v70, 0
    v_mov_b32 v71, 0
    v_mov_b32 v72, 0
    v_mov_b32 v73, 0
    v_mov_b32 v74, 0
    v_mov_b32 v75, 0
    v_mov_b32 v76, 0
    v_mov_b32 v77, 0
    v_mov_b32 v78, 0
    v_mov_b32 v79, 0
    v_mov_b32 v80, 0
    v_mov_b32 v81, 0
    v_mov_b32 v82, 0
    v_mov_b32 v83, 0
    s_mov_b32 s20, 2359296
    s_mov_b32 s14, 0
L_attn_sl2:
    s_and_b32 s24, s14, 3
    s_mul_i32 s24, s24, 2428
    s_sub_u32 s24, s20, s24
    buffer_load_dwordx4 v[84:87], v112, s[8:11], s20 offen
    buffer_load_dword v92, v113, s[8:11], s24 offen offset:1024
    buffer_load_dwordx4 v[96:99], v114, s[8:11], s20 offen offset:1152
    buffer_load_dwordx4 v[100:103], v114, s[8:11], s20 offen offset:1792
    s_add_u32 s20, s20, 2432
    s_waitcnt vmcnt(0)
    v_mfma_f32_32x32x16_bf16 v[28:43], v[84:87], v[4:7], v[12:27]
    v_mfma_f32_32x32x8_bf16 v[28:43], v[92:93], v[8:9], v[28:43]
    s_add_u32 s14, s14, 1
    s_nop 15
    v_exp_f32 v28, v28
    v_exp_f32 v29, v29
    v_exp_f32 v30, v30
    v_exp_f32 v31, v31
    v_exp_f32 v32, v32
    v_exp_f32 v33, v33
    v_exp_f32 v34, v34
    v_exp_f32 v35, v35
    v_exp_f32 v36, v36
    v_exp_f32 v37, v37
    v_exp_f32 v38, v38
    v_exp_f32 v39, v39
    v_exp_f32 v40, v40
    v_exp_f32 v41, v41
    v_exp_f32 v42, v42
    v_exp_f32 v43, v43
    s_nop 0
    v_cvt_pk_bf16_f32 v60, v28, v29
    v_cvt_pk_bf16_f32 v61, v30, v31
    v_cvt_pk_bf16_f32 v62, v32, v33
    v_cvt_pk_bf16_f32 v63, v34, v35
    v_cvt_pk_bf16_f32 v64, v36, v37
    v_cvt_pk_bf16_f32 v65, v38, v39
    v_cvt_pk_bf16_f32 v66, v40, v41
    v_cvt_pk_bf16_f32 v67, v42, v43
    s_nop 1
    v_mfma_f32_32x32x16_bf16 v[68:83], v[96:99], v[60:63], v[68:83]
    v_mfma_f32_32x32x16_bf16 v[68:83], v[100:103], v[64:67], v[68:83]
    s_cmp_lt_u32 s14, 64
    s_cbranch_scc1 L_attn_sl2
    s_nop 15
    v_mov_b32 v115, v78
    v_mov_b32 v116, v78
    s_nop 1
    v_permlane32_swap_b32 v115, v116
    s_nop 1
    s_branch L_attn_ok
L_k2_a:
    s_cmp_ge_u32 s2, 512
    s_cbranch_scc1 L_k2_end
    s_load_dwordx4 s[40:43], s[0:1], 0
    s_load_dwordx2 s[56:57], s[0:1], 80
    v_lshrrev_b32 v1, 6, v0
    s_and_b32 s3, s2, 7
    v_readfirstlane_b32 s27, v1
    s_bfe_u32 s4, s2, 0x50003
    s_lshl_b32 s36, s3, 2
    s_and_b32 s5, s4, 3
    s_add_u32 s36, s36, s5
    s_lshr_b32 s37, s4, 2
    s_cmp_eq_u32 s36, 0
    s_cselect_b32 s38, 0, 14
    s_lshl_b32 s20, s36, 6
    s_sub_u32 s20, s20, s38
    s_mul_i32 s20, s20, 1152
    s_mul_i32 s21, s37, 144
    s_mov_b32 s22, 3456
    s_cmp_ge_u32 s27, 4
    s_cbranch_scc1 L_ar_w4
    v_and_b32 v1, 63, v0
    s_lshl_b32 s29, s27, 3
    v_lshrrev_b32 v6, 3, v1
    v_add_u32 v6, s29, v6
    v_mul_u32_u24 v6, 1152, v6
    v_lshrrev_b32 v7, 4, v1
    s_lshl_b32 s29, s27, 2
    v_add_u32 v7, s29, v7
    v_and_b32 v7, 7, v7
    v_and_b32 v8, 7, v1
    v_xor_b32 v7, v7, v8
    v_lshl_add_u32 v103, v7, 4, v6
    v_add_u32 v104, 36864, v103
    v_add_u32 v105, 73728, v103
    v_lshrrev_b32 v6, 3, v1
    s_lshl_b32 s29, s27, 3
    v_add_u32 v6, s29, v6
    v_mov_b32 v7, 0x7fffff00
    v_cmp_gt_u32 vcc, s38, v6
    s_nop 1
    v_cndmask_b32 v105, v7, v105, vcc
    s_lshl_b32 s33, s27, 10
    s_add_u32 s33, s33, 57344
    s_mov_b32 s28, 9586981
    v_lshlrev_b32 v6, 4, v1
    v_mul_hi_u32 v7, v6, s28
    v_mul_u32_u24 v8, 448, v7
    v_sub_u32 v8, v6, v8
    v_mul_lo_u32 v7, v7, s22
    v_lshrrev_b32 v9, 4, v8
    v_mul_u32_u24 v9, 57, v9
    v_lshrrev_b32 v9, 9, v9
    v_min_u32 v9, 2, v9
    v_mul_u32_u24 v9, 1008, v9
    v_add_u32 v8, v8, v9
    v_add_u32 v96, v7, v8
    v_cmp_gt_u32 vcc, 2448, v8
    v_mov_b32 v7, 0x7fffff00
    s_nop 0
    v_cndmask_b32 v96, v7, v96, vcc
    v_lshlrev_b32 v6, 4, v1
    v_add_u32 v6, 1024, v6
    v_mul_hi_u32 v7, v6, s28
    v_mul_u32_u24 v8, 448, v7
    v_sub_u32 v8, v6, v8
    v_mul_lo_u32 v7, v7, s22
    v_lshrrev_b32 v9, 4, v8
    v_mul_u32_u24 v9, 57, v9
    v_lshrrev_b32 v9, 9, v9
    v_min_u32 v9, 2, v9
    v_mul_u32_u24 v9, 1008, v9
    v_add_u32 v8, v8, v9
    v_add_u32 v97, v7, v8
    v_cmp_gt_u32 vcc, 2448, v8
    v_mov_b32 v7, 0x7fffff00
    s_nop 0
    v_cndmask_b32 v97, v7, v97, vcc
    v_lshlrev_b32 v6, 4, v1
    v_add_u32 v6, 2048, v6
    v_mul_hi_u32 v7, v6, s28
    v_mul_u32_u24 v8, 448, v7
    v_sub_u32 v8, v6, v8
    v_mul_lo_u32 v7, v7, s22
    v_lshrrev_b32 v9, 4, v8
    v_mul_u32_u24 v9, 57, v9
    v_lshrrev_b32 v9, 9, v9
    v_min_u32 v9, 2, v9
    v_mul_u32_u24 v9, 1008, v9
    v_add_u32 v8, v8, v9
    v_add_u32 v98, v7, v8
    v_cmp_gt_u32 vcc, 2448, v8
    v_mov_b32 v7, 0x7fffff00
    s_nop 0
    v_cndmask_b32 v98, v7, v98, vcc
    v_lshlrev_b32 v6, 4, v1
    v_add_u32 v6, 3072, v6
    v_mul_hi_u32 v7, v6, s28
    v_mul_u32_u24 v8, 448, v7
    v_sub_u32 v8, v6, v8
    v_mul_lo_u32 v7, v7, s22
    v_lshrrev_b32 v9, 4, v8
    v_mul_u32_u24 v9, 57, v9
    v_lshrrev_b32 v9, 9, v9
    v_min_u32 v9, 2, v9
    v_mul_u32_u24 v9, 1008, v9
    v_add_u32 v8, v8, v9
    v_add_u32 v99, v7, v8
    v_cmp_gt_u32 vcc, 2448, v8
    v_mov_b32 v7, 0x7fffff00
    s_nop 0
    v_cndmask_b32 v99, v7, v99, vcc
    v_lshlrev_b32 v6, 4, v1
    v_add_u32 v6, 4096, v6
    v_mul_hi_u32 v7, v6, s28
    v_mul_u32_u24 v8, 448, v7
    v_sub_u32 v8, v6, v8
    v_mul_lo_u32 v7, v7, s22
    v_lshrrev_b32 v9, 4, v8
    v_mul_u32_u24 v9, 57, v9
    v_lshrrev_b32 v9, 9, v9
    v_min_u32 v9, 2, v9
    v_mul_u32_u24 v9, 1008, v9
    v_add_u32 v8, v8, v9
    v_add_u32 v100, v7, v8
    v_cmp_gt_u32 vcc, 2448, v8
    v_mov_b32 v7, 0x7fffff00
    s_nop 0
    v_cndmask_b32 v100, v7, v100, vcc
    v_lshlrev_b32 v6, 4, v1
    v_add_u32 v6, 5120, v6
    v_mul_hi_u32 v7, v6, s28
    v_mul_u32_u24 v8, 448, v7
    v_sub_u32 v8, v6, v8
    v_mul_lo_u32 v7, v7, s22
    v_lshrrev_b32 v9, 4, v8
    v_mul_u32_u24 v9, 57, v9
    v_lshrrev_b32 v9, 9, v9
    v_min_u32 v9, 2, v9
    v_mul_u32_u24 v9, 1008, v9
    v_add_u32 v8, v8, v9
    v_add_u32 v101, v7, v8
    v_cmp_gt_u32 vcc, 2448, v8
    v_mov_b32 v7, 0x7fffff00
    s_nop 0
    v_cndmask_b32 v101, v7, v101, vcc
    v_lshlrev_b32 v6, 4, v1
    v_add_u32 v6, 6144, v6
    v_mul_hi_u32 v7, v6, s28
    v_mul_u32_u24 v8, 448, v7
    v_sub_u32 v8, v6, v8
    v_mul_lo_u32 v7, v7, s22
    v_lshrrev_b32 v9, 4, v8
    v_mul_u32_u24 v9, 57, v9
    v_lshrrev_b32 v9, 9, v9
    v_min_u32 v9, 2, v9
    v_mul_u32_u24 v9, 1008, v9
    v_add_u32 v8, v8, v9
    v_add_u32 v102, v7, v8
    v_cmp_gt_u32 vcc, 2448, v8
    v_mov_b32 v7, 0x7fffff00
    s_nop 0
    v_cndmask_b32 v102, v7, v102, vcc
    s_lshl_b32 s31, s22, 4
    s_mul_i32 s30, s31, s27
    s_add_u32 s30, s30, s21
    s_lshl_b32 s31, s22, 6
    s_mul_i32 s32, s27, 7168
    s_waitcnt lgkmcnt(0)
    s_mov_b32 s8, s40
    s_mov_b32 s9, s41
    s_mov_b32 s10, 2359296
    s_mov_b32 s11, 0x00020000
    s_mov_b32 s12, s42
    s_mov_b32 s13, s43
    s_mov_b32 s14, 1990656
    s_mov_b32 s15, 0x00020000
    s_mov_b32 s16, s56
    s_mov_b32 s17, s57
    s_mov_b32 s18, 16777216
    s_mov_b32 s19, 0x00020000
    s_add_u32 m0, s32, 0
    s_nop 0
    buffer_load_dwordx4 v96, s[12:15], s30 offen lds
    s_add_u32 m0, s32, 1024
    s_nop 0
    buffer_load_dwordx4 v97, s[12:15], s30 offen lds
    s_add_u32 m0, s32, 2048
    s_nop 0
    buffer_load_dwordx4 v98, s[12:15], s30 offen lds
    s_add_u32 m0, s32, 3072
    s_nop 0
    buffer_load_dwordx4 v99, s[12:15], s30 offen lds
    s_add_u32 m0, s32, 4096
    s_nop 0
    buffer_load_dwordx4 v100, s[12:15], s30 offen lds
    s_add_u32 m0, s32, 5120
    s_nop 0
    buffer_load_dwordx4 v101, s[12:15], s30 offen lds
    s_add_u32 m0, s32, 6144
    s_nop 0
    buffer_load_dwordx4 v102, s[12:15], s30 offen lds
    s_add_u32 s30, s30, s31
    s_add_u32 m0, s33, 0
    s_nop 0
    buffer_load_dwordx4 v103, s[8:11], s20 offen lds
    s_add_u32 m0, s33, 4096
    s_nop 0
    buffer_load_dwordx4 v104, s[8:11], s20 offen lds
    s_add_u32 m0, s33, 8192
    s_nop 0
    buffer_load_dwordx4 v105, s[8:11], s20 offen lds
    s_add_u32 s20, s20, 128
    s_add_u32 m0, s32, 28672
    s_nop 0
    buffer_load_dwordx4 v96, s[12:15], s30 offen lds
    s_add_u32 m0, s32, 29696
    s_nop 0
    buffer_load_dwordx4 v97, s[12:15], s30 offen lds
    s_add_u32 m0, s32, 30720
    s_nop 0
    buffer_load_dwordx4 v98, s[12:15], s30 offen lds
    s_add_u32 m0, s32, 31744
    s_nop 0
    buffer_load_dwordx4 v99, s[12:15], s30 offen lds
    s_add_u32 m0, s32, 32768
    s_nop 0
    buffer_load_dwordx4 v100, s[12:15], s30 offen lds
    s_add_u32 m0, s32, 33792
    s_nop 0
    buffer_load_dwordx4 v101, s[12:15], s30 offen lds
    s_add_u32 m0, s32, 34816
    s_nop 0
    buffer_load_dwordx4 v102, s[12:15], s30 offen lds
    s_add_u32 s30, s30, s31
    s_add_u32 m0, s33, 12288
    s_nop 0
    buffer_load_dwordx4 v103, s[8:11], s20 offen lds
    s_add_u32 m0, s33, 16384
    s_nop 0
    buffer_load_dwordx4 v104, s[8:11], s20 offen lds
    s_add_u32 m0, s33, 20480
    s_nop 0
    buffer_load_dwordx4 v105, s[8:11], s20 offen lds
    s_add_u32 s20, s20, 128
    v_and_b32 v1, 63, v0
    s_mov_b32 s34, 0
    s_mov_b32 s35, s27
    v_lshrrev_b32 v6, 5, v1
    v_lshlrev_b32 v6, 3, v6
    v_bfe_u32 v7, v1, 2, 2
    v_add_u32 v6, v6, v7
    v_mul_u32_u24 v6, 448, v6
    v_bfe_u32 v7, v1, 4, 1
    v_lshlrev_b32 v7, 5, v7
    v_and_b32 v8, 3, v1
    v_lshlrev_b32 v8, 3, v8
    v_add3_u32 v2, v6, v7, v8
    s_mul_i32 s28, s35, 64
    v_add_u32 v2, s28, v2
    v_add_u32 v3, 57344, v2
    v_add_u32 v4, 114688, v2
    v_add_u32 v5, 172032, v2
    v_and_b32 v6, 31, v1
    v_lshrrev_b32 v7, 5, v1
    v_bfe_u32 v8, v1, 1, 3
    v_lshlrev_b32 v10, 7, v6
    s_mul_i32 s28, s34, 12288
    s_add_u32 s28, s28, 57344
    v_add_u32 v10, s28, v10
    v_add_u32 v9, 0, v7
    v_xor_b32 v9, v9, v8
    v_lshl_add_u32 v106, v9, 4, v10
    v_add_u32 v9, 2, v7
    v_xor_b32 v9, v9, v8
    v_lshl_add_u32 v107, v9, 4, v10
    v_add_u32 v9, 4, v7
    v_xor_b32 v9, v9, v8
    v_lshl_add_u32 v108, v9, 4, v10
    v_add_u32 v9, 6, v7
    v_xor_b32 v9, v9, v8
    v_lshl_add_u32 v109, v9, 4, v10
    s_mul_i32 s28, s34, 44544
    s_mul_i32 s29, s35, 64
    s_add_u32 s28, s28, s29
    v_mul_u32_u24 v6, 464, v6
    v_lshl_add_u32 v6, v7, 4, v6
    v_add_u32 v114, s28, v6
    s_waitcnt vmcnt(10) lgkmcnt(0)
    s_barrier
    ds_read_b64_tr_b16 v[64:65], v2 offset:0
    ds_read_b64_tr_b16 v[66:67], v2 offset:1792
    ds_read_b128 v[72:75], v106 offset:0
    ds_read_b128 v[76:79], v106 offset:4096
    ds_read_b128 v[80:83], v106 offset:8192
    s_waitcnt lgkmcnt(0)
    v_mfma_f32_32x32x16_bf16 v[16:31], v[64:67], v[72:75], 0
    ds_read_b64_tr_b16 v[68:69], v2 offset:7168
    ds_read_b64_tr_b16 v[70:71], v2 offset:8960
    v_mfma_f32_32x32x16_bf16 v[32:47], v[64:67], v[76:79], 0
    ds_read_b128 v[84:87], v107 offset:0
    ds_read_b128 v[88:91], v107 offset:4096
    v_mfma_f32_32x32x16_bf16 v[48:63], v[64:67], v[80:83], 0
    ds_read_b128 v[92:95], v107 offset:8192
    s_waitcnt lgkmcnt(0)
    v_mfma_f32_32x32x16_bf16 v[16:31], v[68:71], v[84:87], v[16:31]
    ds_read_b64_tr_b16 v[64:65], v2 offset:14336
    ds_read_b64_tr_b16 v[66:67], v2 offset:16128
    v_mfma_f32_32x32x16_bf16 v[32:47], v[68:71], v[88:91], v[32:47]
    ds_read_b128 v[72:75], v108 offset:0
    ds_read_b128 v[76:79], v108 offset:4096
    v_mfma_f32_32x32x16_bf16 v[48:63], v[68:71], v[92:95], v[48:63]
    ds_read_b128 v[80:83], v108 offset:8192
    s_waitcnt lgkmcnt(0)
    v_mfma_f32_32x32x16_bf16 v[16:31], v[64:67], v[72:75], v[16:31]
    ds_read_b64_tr_b16 v[68:69], v2 offset:21504
    ds_read_b64_tr_b16 v[70:71], v2 offset:23296
    v_mfma_f32_32x32x16_bf16 v[32:47], v[64:67], v[76:79], v[32:47]
    ds_read_b128 v[84:87], v109 offset:0
    ds_read_b128 v[88:91], v109 offset:4096
    v_mfma_f32_32x32x16_bf16 v[48:63], v[64:67], v[80:83], v[48:63]
    ds_read_b128 v[92:95], v109 offset:8192
    s_waitcnt vmcnt(0) lgkmcnt(0)
    s_barrier
    v_mfma_f32_32x32x16_bf16 v[16:31], v[68:71], v[84:87], v[16:31]
    ds_read_b64_tr_b16 v[64:65], v2 offset:28672
    ds_read_b64_tr_b16 v[66:67], v2 offset:30464
    s_add_u32 m0, s32, 0
    s_nop 0
    buffer_load_dwordx4 v96, s[12:15], s30 offen lds
    v_mfma_f32_32x32x16_bf16 v[32:47], v[68:71], v[88:91], v[32:47]
    ds_read_b128 v[72:75], v106 offset:12288
    ds_read_b128 v[76:79], v106 offset:16384
    s_add_u32 m0, s32, 1024
    s_nop 0
    buffer_load_dwordx4 v97, s[12:15], s30 offen lds
    v_mfma_f32_32x32x16_bf16 v[48:63], v[68:71], v[92:95], v[48:63]
    ds_read_b128 v[80:83], v106 offset:20480
    s_add_u32 m0, s32, 2048
    s_nop 0
    buffer_load_dwordx4 v98, s[12:15], s30 offen lds
    s_waitcnt lgkmcnt(0)
    v_mfma_f32_32x32x16_bf16 v[16:31], v[64:67], v[72:75], v[16:31]
    ds_read_b64_tr_b16 v[68:69], v2 offset:35840
    ds_read_b64_tr_b16 v[70:71], v2 offset:37632
    s_add_u32 m0, s32, 3072
    s_nop 0
    buffer_load_dwordx4 v99, s[12:15], s30 offen lds
    v_mfma_f32_32x32x16_bf16 v[32:47], v[64:67], v[76:79], v[32:47]
    ds_read_b128 v[84:87], v107 offset:12288
    ds_read_b128 v[88:91], v107 offset:16384
    s_add_u32 m0, s32, 4096
    s_nop 0
    buffer_load_dwordx4 v100, s[12:15], s30 offen lds
    v_mfma_f32_32x32x16_bf16 v[48:63], v[64:67], v[80:83], v[48:63]
    ds_read_b128 v[92:95], v107 offset:20480
    s_add_u32 m0, s32, 5120
    s_nop 0
    buffer_load_dwordx4 v101, s[12:15], s30 offen lds
    s_waitcnt lgkmcnt(0)
    v_mfma_f32_32x32x16_bf16 v[16:31], v[68:71], v[84:87], v[16:31]
    ds_read_b64_tr_b16 v[64:65], v2 offset:43008
    ds_read_b64_tr_b16 v[66:67], v2 offset:44800
    v_mfma_f32_32x32x16_bf16 v[32:47], v[68:71], v[88:91], v[32:47]
    ds_read_b128 v[72:75], v108 offset:12288
    ds_read_b128 v[76:79], v108 offset:16384
    s_add_u32 m0, s32, 6144
    s_nop 0
    buffer_load_dwordx4 v102, s[12:15], s30 offen lds
    s_add_u32 s30, s30, s31
    v_mfma_f32_32x32x16_bf16 v[48:63], v[68:71], v[92:95], v[48:63]
    ds_read_b128 v[80:83], v108 offset:20480
    s_add_u32 m0, s33, 0
    s_nop 0
    buffer_load_dwordx4 v103, s[8:11], s20 offen lds
    s_waitcnt lgkmcnt(0)
    v_mfma_f32_32x32x16_bf16 v[16:31], v[64:67], v[72:75], v[16:31]
    ds_read_b64_tr_b16 v[68:69], v2 offset:50176
    ds_read_b64_tr_b16 v[70:71], v2 offset:51968
    v_mfma_f32_32x32x16_bf16 v[32:47], v[64:67], v[76:79], v[32:47]
    ds_read_b128 v[84:87], v109 offset:12288
    ds_read_b128 v[88:91], v109 offset:16384
    s_add_u32 m0, s33, 4096
    s_nop 0
    buffer_load_dwordx4 v104, s[8:11], s20 offen lds
    v_mfma_f32_32x32x16_bf16 v[48:63], v[64:67], v[80:83], v[48:63]
    ds_read_b128 v[92:95], v109 offset:20480
    s_add_u32 m0, s33, 8192
    s_nop 0
    buffer_load_dwordx4 v105, s[8:11], s20 offen lds
    s_add_u32 s20, s20, 128
    s_waitcnt vmcnt(0) lgkmcnt(0)
    s_barrier
    v_mfma_f32_32x32x16_bf16 v[16:31], v[68:71], v[84:87], v[16:31]
    ds_read_b64_tr_b16 v[64:65], v2 offset:0
    ds_read_b64_tr_b16 v[66:67], v2 offset:1792
    s_add_u32 m0, s32, 28672
    s_nop 0
    buffer_load_dwordx4 v96, s[12:15], s30 offen lds
    v_mfma_f32_32x32x16_bf16 v[32:47], v[68:71], v[88:91], v[32:47]
    ds_read_b128 v[72:75], v106 offset:0
    ds_read_b128 v[76:79], v106 offset:4096
    s_add_u32 m0, s32, 29696
    s_nop 0
    buffer_load_dwordx4 v97, s[12:15], s30 offen lds
    v_mfma_f32_32x32x16_bf16 v[48:63], v[68:71], v[92:95], v[48:63]
    ds_read_b128 v[80:83], v106 offset:8192
    s_add_u32 m0, s32, 30720
    s_nop 0
    buffer_load_dwordx4 v98, s[12:15], s30 offen lds
    s_waitcnt lgkmcnt(0)
    v_mfma_f32_32x32x16_bf16 v[16:31], v[64:67], v[72:75], v[16:31]
    ds_read_b64_tr_b16 v[68:69], v2 offset:7168
    ds_read_b64_tr_b16 v[70:71], v2 offset:8960
    s_add_u32 m0, s32, 31744
    s_nop 0
    buffer_load_dwordx4 v99, s[12:15], s30 offen lds
    v_mfma_f32_32x32x16_bf16 v[32:47], v[64:67], v[76:79], v[32:47]
    ds_read_b128 v[84:87], v107 offset:0
    ds_read_b128 v[88:91], v107 offset:4096
    s_add_u32 m0, s32, 32768
    s_nop 0
    buffer_load_dwordx4 v100, s[12:15], s30 offen lds
    v_mfma_f32_32x32x16_bf16 v[48:63], v[64:67], v[80:83], v[48:63]
    ds_read_b128 v[92:95], v107 offset:8192
    s_add_u32 m0, s32, 33792
    s_nop 0
    buffer_load_dwordx4 v101, s[12:15], s30 offen lds
    s_waitcnt lgkmcnt(0)
    v_mfma_f32_32x32x16_bf16 v[16:31], v[68:71], v[84:87], v[16:31]
    ds_read_b64_tr_b16 v[64:65], v2 offset:14336
    ds_read_b64_tr_b16 v[66:67], v2 offset:16128
    v_mfma_f32_32x32x16_bf16 v[32:47], v[68:71], v[88:91], v[32:47]
    ds_read_b128 v[72:75], v108 offset:0
    ds_read_b128 v[76:79], v108 offset:4096
    s_add_u32 m0, s32, 34816
    s_nop 0
    buffer_load_dwordx4 v102, s[12:15], s30 offen lds
    s_add_u32 s30, s30, s31
    v_mfma_f32_32x32x16_bf16 v[48:63], v[68:71], v[92:95], v[48:63]
    ds_read_b128 v[80:83], v108 offset:8192
    s_add_u32 m0, s33, 12288
    s_nop 0
    buffer_load_dwordx4 v103, s[8:11], s20 offen lds
    s_waitcnt lgkmcnt(0)
    v_mfma_f32_32x32x16_bf16 v[16:31], v[64:67], v[72:75], v[16:31]
    ds_read_b64_tr_b16 v[68:69], v2 offset:21504
    ds_read_b64_tr_b16 v[70:71], v2 offset:23296
    v_mfma_f32_32x32x16_bf16 v[32:47], v[64:67], v[76:79], v[32:47]
    ds_read_b128 v[84:87], v109 offset:0
    ds_read_b128 v[88:91], v109 offset:4096
    s_add_u32 m0, s33, 16384
    s_nop 0
    buffer_load_dwordx4 v104, s[8:11], s20 offen lds
    v_mfma_f32_32x32x16_bf16 v[48:63], v[64:67], v[80:83], v[48:63]
    ds_read_b128 v[92:95], v109 offset:8192
    s_add_u32 m0, s33, 20480
    s_nop 0
    buffer_load_dwordx4 v105, s[8:11], s20 offen lds
    s_add_u32 s20, s20, 128
    s_waitcnt vmcnt(0) lgkmcnt(0)
    s_barrier
    v_mfma_f32_32x32x16_bf16 v[16:31], v[68:71], v[84:87], v[16:31]
    ds_read_b64_tr_b16 v[64:65], v2 offset:28672
    ds_read_b64_tr_b16 v[66:67], v2 offset:30464
    s_add_u32 m0, s32, 0
    s_nop 0
    buffer_load_dwordx4 v96, s[12:15], s30 offen lds
    v_mfma_f32_32x32x16_bf16 v[32:47], v[68:71], v[88:91], v[32:47]
    ds_read_b128 v[72:75], v106 offset:12288
    ds_read_b128 v[76:79], v106 offset:16384
    s_add_u32 m0, s32, 1024
    s_nop 0
    buffer_load_dwordx4 v97, s[12:15], s30 offen lds
    v_mfma_f32_32x32x16_bf16 v[48:63], v[68:71], v[92:95], v[48:63]
    ds_read_b128 v[80:83], v106 offset:20480
    s_add_u32 m0, s32, 2048
    s_nop 0
    buffer_load_dwordx4 v98, s[12:15], s30 offen lds
    s_waitcnt lgkmcnt(0)
    v_mfma_f32_32x32x16_bf16 v[16:31], v[64:67], v[72:75], v[16:31]
    ds_read_b64_tr_b16 v[68:69], v2 offset:35840
    ds_read_b64_tr_b16 v[70:71], v2 offset:37632
    s_add_u32 m0, s32, 3072
    s_nop 0
    buffer_load_dwordx4 v99, s[12:15], s30 offen lds
    v_mfma_f32_32x32x16_bf16 v[32:47], v[64:67], v[76:79], v[32:47]
    ds_read_b128 v[84:87], v107 offset:12288
    ds_read_b128 v[88:91], v107 offset:16384
    s_add_u32 m0, s32, 4096
    s_nop 0
    buffer_load_dwordx4 v100, s[12:15], s30 offen lds
    v_mfma_f32_32x32x16_bf16 v[48:63], v[64:67], v[80:83], v[48:63]
    ds_read_b128 v[92:95], v107 offset:20480
    s_add_u32 m0, s32, 5120
    s_nop 0
    buffer_load_dwordx4 v101, s[12:15], s30 offen lds
    s_waitcnt lgkmcnt(0)
    v_mfma_f32_32x32x16_bf16 v[16:31], v[68:71], v[84:87], v[16:31]
    ds_read_b64_tr_b16 v[64:65], v2 offset:43008
    ds_read_b64_tr_b16 v[66:67], v2 offset:44800
    v_mfma_f32_32x32x16_bf16 v[32:47], v[68:71], v[88:91], v[32:47]
    ds_read_b128 v[72:75], v108 offset:12288
    ds_read_b128 v[76:79], v108 offset:16384
    s_add_u32 m0, s32, 6144
    s_nop 0
    buffer_load_dwordx4 v102, s[12:15], s30 offen lds
    s_add_u32 s30, s30, s31
    v_mfma_f32_32x32x16_bf16 v[48:63], v[68:71], v[92:95], v[48:63]
    ds_read_b128 v[80:83], v108 offset:20480
    s_add_u32 m0, s33, 0
    s_nop 0
    buffer_load_dwordx4 v103, s[8:11], s20 offen lds
    s_waitcnt lgkmcnt(0)
    v_mfma_f32_32x32x16_bf16 v[16:31], v[64:67], v[72:75], v[16:31]
    ds_read_b64_tr_b16 v[68:69], v2 offset:50176
    ds_read_b64_tr_b16 v[70:71], v2 offset:51968
    v_mfma_f32_32x32x16_bf16 v[32:47], v[64:67], v[76:79], v[32:47]
    ds_read_b128 v[84:87], v109 offset:12288
    ds_read_b128 v[88:91], v109 offset:16384
    s_add_u32 m0, s33, 4096
    s_nop 0
    buffer_load_dwordx4 v104, s[8:11], s20 offen lds
    v_mfma_f32_32x32x16_bf16 v[48:63], v[64:67], v[80:83], v[48:63]
    ds_read_b128 v[92:95], v109 offset:20480
    s_add_u32 m0, s33, 8192
    s_nop 0
    buffer_load_dwordx4 v105, s[8:11], s20 offen lds
    s_add_u32 s20, s20, 128
    s_waitcnt vmcnt(0) lgkmcnt(0)
    s_barrier
    v_mfma_f32_32x32x16_bf16 v[16:31], v[68:71], v[84:87], v[16:31]
    ds_read_b64_tr_b16 v[64:65], v2 offset:0
    ds_read_b64_tr_b16 v[66:67], v2 offset:1792
    s_add_u32 m0, s32, 28672
    s_nop 0
    buffer_load_dwordx4 v96, s[12:15], s30 offen lds
    v_mfma_f32_32x32x16_bf16 v[32:47], v[68:71], v[88:91], v[32:47]
    ds_read_b128 v[72:75], v106 offset:0
    ds_read_b128 v[76:79], v106 offset:4096
    s_add_u32 m0, s32, 29696
    s_nop 0
    buffer_load_dwordx4 v97, s[12:15], s30 offen lds
    v_mfma_f32_32x32x16_bf16 v[48:63], v[68:71], v[92:95], v[48:63]
    ds_read_b128 v[80:83], v106 offset:8192
    s_add_u32 m0, s32, 30720
    s_nop 0
    buffer_load_dwordx4 v98, s[12:15], s30 offen lds
    s_waitcnt lgkmcnt(0)
    v_mfma_f32_32x32x16_bf16 v[16:31], v[64:67], v[72:75], v[16:31]
    ds_read_b64_tr_b16 v[68:69], v2 offset:7168
    ds_read_b64_tr_b16 v[70:71], v2 offset:8960
    s_add_u32 m0, s32, 31744
    s_nop 0
    buffer_load_dwordx4 v99, s[12:15], s30 offen lds
    v_mfma_f32_32x32x16_bf16 v[32:47], v[64:67], v[76:79], v[32:47]
    ds_read_b128 v[84:87], v107 offset:0
    ds_read_b128 v[88:91], v107 offset:4096
    s_add_u32 m0, s32, 32768
    s_nop 0
    buffer_load_dwordx4 v100, s[12:15], s30 offen lds
    v_mfma_f32_32x32x16_bf16 v[48:63], v[64:67], v[80:83], v[48:63]
    ds_read_b128 v[92:95], v107 offset:8192
    s_add_u32 m0, s32, 33792
    s_nop 0
    buffer_load_dwordx4 v101, s[12:15], s30 offen lds
    s_waitcnt lgkmcnt(0)
    v_mfma_f32_32x32x16_bf16 v[16:31], v[68:71], v[84:87], v[16:31]
    ds_read_b64_tr_b16 v[64:65], v2 offset:14336
    ds_read_b64_tr_b16 v[66:67], v2 offset:16128
    v_mfma_f32_32x32x16_bf16 v[32:47], v[68:71], v[88:91], v[32:47]
    ds_read_b128 v[72:75], v108 offset:0
    ds_read_b128 v[76:79], v108 offset:4096
    s_add_u32 m0, s32, 34816
    s_nop 0
    buffer_load_dwordx4 v102, s[12:15], s30 offen lds
    s_add_u32 s30, s30, s31
    v_mfma_f32_32x32x16_bf16 v[48:63], v[68:71], v[92:95], v[48:63]
    ds_read_b128 v[80:83], v108 offset:8192
    s_add_u32 m0, s33, 12288
    s_nop 0
    buffer_load_dwordx4 v103, s[8:11], s20 offen lds
    s_waitcnt lgkmcnt(0)
    v_mfma_f32_32x32x16_bf16 v[16:31], v[64:67], v[72:75], v[16:31]
    ds_read_b64_tr_b16 v[68:69], v2 offset:21504
    ds_read_b64_tr_b16 v[70:71], v2 offset:23296
    v_mfma_f32_32x32x16_bf16 v[32:47], v[64:67], v[76:79], v[32:47]
    ds_read_b128 v[84:87], v109 offset:0
    ds_read_b128 v[88:91], v109 offset:4096
    s_add_u32 m0, s33, 16384
    s_nop 0
    buffer_load_dwordx4 v104, s[8:11], s20 offen lds
    v_mfma_f32_32x32x16_bf16 v[48:63], v[64:67], v[80:83], v[48:63]
    ds_read_b128 v[92:95], v109 offset:8192
    s_add_u32 m0, s33, 20480
    s_nop 0
    buffer_load_dwordx4 v105, s[8:11], s20 offen lds
    s_add_u32 s20, s20, 128
    s_waitcnt vmcnt(0) lgkmcnt(0)
    s_barrier
    v_mfma_f32_32x32x16_bf16 v[16:31], v[68:71], v[84:87], v[16:31]
    ds_read_b64_tr_b16 v[64:65], v2 offset:28672
    ds_read_b64_tr_b16 v[66:67], v2 offset:30464
    s_add_u32 m0, s32, 0
    s_nop 0
    buffer_load_dwordx4 v96, s[12:15], s30 offen lds
    v_mfma_f32_32x32x16_bf16 v[32:47], v[68:71], v[88:91], v[32:47]
    ds_read_b128 v[72:75], v106 offset:12288
    ds_read_b128 v[76:79], v106 offset:16384
    s_add_u32 m0, s32, 1024
    s_nop 0
    buffer_load_dwordx4 v97, s[12:15], s30 offen lds
    v_mfma_f32_32x32x16_bf16 v[48:63], v[68:71], v[92:95], v[48:63]
    ds_read_b128 v[80:83], v106 offset:20480
    s_add_u32 m0, s32, 2048
    s_nop 0
    buffer_load_dwordx4 v98, s[12:15], s30 offen lds
    s_waitcnt lgkmcnt(0)
    v_mfma_f32_32x32x16_bf16 v[16:31], v[64:67], v[72:75], v[16:31]
    ds_read_b64_tr_b16 v[68:69], v2 offset:35840
    ds_read_b64_tr_b16 v[70:71], v2 offset:37632
    s_add_u32 m0, s32, 3072
    s_nop 0
    buffer_load_dwordx4 v99, s[12:15], s30 offen lds
    v_mfma_f32_32x32x16_bf16 v[32:47], v[64:67], v[76:79], v[32:47]
    ds_read_b128 v[84:87], v107 offset:12288
    ds_read_b128 v[88:91], v107 offset:16384
    s_add_u32 m0, s32, 4096
    s_nop 0
    buffer_load_dwordx4 v100, s[12:15], s30 offen lds
    v_mfma_f32_32x32x16_bf16 v[48:63], v[64:67], v[80:83], v[48:63]
    ds_read_b128 v[92:95], v107 offset:20480
    s_add_u32 m0, s32, 5120
    s_nop 0
    buffer_load_dwordx4 v101, s[12:15], s30 offen lds
    s_waitcnt lgkmcnt(0)
    v_mfma_f32_32x32x16_bf16 v[16:31], v[68:71], v[84:87], v[16:31]
    ds_read_b64_tr_b16 v[64:65], v2 offset:43008
    ds_read_b64_tr_b16 v[66:67], v2 offset:44800
    v_mfma_f32_32x32x16_bf16 v[32:47], v[68:71], v[88:91], v[32:47]
    ds_read_b128 v[72:75], v108 offset:12288
    ds_read_b128 v[76:79], v108 offset:16384
    s_add_u32 m0, s32, 6144
    s_nop 0
    buffer_load_dwordx4 v102, s[12:15], s30 offen lds
    s_add_u32 s30, s30, s31
    v_mfma_f32_32x32x16_bf16 v[48:63], v[68:71], v[92:95], v[48:63]
    ds_read_b128 v[80:83], v108 offset:20480
    s_add_u32 m0, s33, 0
    s_nop 0
    buffer_load_dwordx4 v103, s[8:11], s20 offen lds
    s_waitcnt lgkmcnt(0)
    v_mfma_f32_32x32x16_bf16 v[16:31], v[64:67], v[72:75], v[16:31]
    ds_read_b64_tr_b16 v[68:69], v2 offset:50176
    ds_read_b64_tr_b16 v[70:71], v2 offset:51968
    v_mfma_f32_32x32x16_bf16 v[32:47], v[64:67], v[76:79], v[32:47]
    ds_read_b128 v[84:87], v109 offset:12288
    ds_read_b128 v[88:91], v109 offset:16384
    s_add_u32 m0, s33, 4096
    s_nop 0
    buffer_load_dwordx4 v104, s[8:11], s20 offen lds
    v_mfma_f32_32x32x16_bf16 v[48:63], v[64:67], v[80:83], v[48:63]
    ds_read_b128 v[92:95], v109 offset:20480
    s_add_u32 m0, s33, 8192
    s_nop 0
    buffer_load_dwordx4 v105, s[8:11], s20 offen lds
    s_add_u32 s20, s20, 128
    s_waitcnt vmcnt(0) lgkmcnt(0)
    s_barrier
    v_mfma_f32_32x32x16_bf16 v[16:31], v[68:71], v[84:87], v[16:31]
    ds_read_b64_tr_b16 v[64:65], v2 offset:0
    ds_read_b64_tr_b16 v[66:67], v2 offset:1792
    s_add_u32 m0, s32, 28672
    s_nop 0
    buffer_load_dwordx4 v96, s[12:15], s30 offen lds
    v_mfma_f32_32x32x16_bf16 v[32:47], v[68:71], v[88:91], v[32:47]
    ds_read_b128 v[72:75], v106 offset:0
    ds_read_b128 v[76:79], v106 offset:4096
    s_add_u32 m0, s32, 29696
    s_nop 0
    buffer_load_dwordx4 v97, s[12:15], s30 offen lds
    v_mfma_f32_32x32x16_bf16 v[48:63], v[68:71], v[92:95], v[48:63]
    ds_read_b128 v[80:83], v106 offset:8192
    s_add_u32 m0, s32, 30720
    s_nop 0
    buffer_load_dwordx4 v98, s[12:15], s30 offen lds
    s_waitcnt lgkmcnt(0)
    v_mfma_f32_32x32x16_bf16 v[16:31], v[64:67], v[72:75], v[16:31]
    ds_read_b64_tr_b16 v[68:69], v2 offset:7168
    ds_read_b64_tr_b16 v[70:71], v2 offset:8960
    s_add_u32 m0, s32, 31744
    s_nop 0
    buffer_load_dwordx4 v99, s[12:15], s30 offen lds
    v_mfma_f32_32x32x16_bf16 v[32:47], v[64:67], v[76:79], v[32:47]
    ds_read_b128 v[84:87], v107 offset:0
    ds_read_b128 v[88:91], v107 offset:4096
    s_add_u32 m0, s32, 32768
    s_nop 0
    buffer_load_dwordx4 v100, s[12:15], s30 offen lds
    v_mfma_f32_32x32x16_bf16 v[48:63], v[64:67], v[80:83], v[48:63]
    ds_read_b128 v[92:95], v107 offset:8192
    s_add_u32 m0, s32, 33792
    s_nop 0
    buffer_load_dwordx4 v101, s[12:15], s30 offen lds
    s_waitcnt lgkmcnt(0)
    v_mfma_f32_32x32x16_bf16 v[16:31], v[68:71], v[84:87], v[16:31]
    ds_read_b64_tr_b16 v[64:65], v2 offset:14336
    ds_read_b64_tr_b16 v[66:67], v2 offset:16128
    v_mfma_f32_32x32x16_bf16 v[32:47], v[68:71], v[88:91], v[32:47]
    ds_read_b128 v[72:75], v108 offset:0
    ds_read_b128 v[76:79], v108 offset:4096
    s_add_u32 m0, s32, 34816
    s_nop 0
    buffer_load_dwordx4 v102, s[12:15], s30 offen lds
    s_add_u32 s30, s30, s31
    v_mfma_f32_32x32x16_bf16 v[48:63], v[68:71], v[92:95], v[48:63]
    ds_read_b128 v[80:83], v108 offset:8192
    s_add_u32 m0, s33, 12288
    s_nop 0
    buffer_load_dwordx4 v103, s[8:11], s20 offen lds
    s_waitcnt lgkmcnt(0)
    v_mfma_f32_32x32x16_bf16 v[16:31], v[64:67], v[72:75], v[16:31]
    ds_read_b64_tr_b16 v[68:69], v2 offset:21504
    ds_read_b64_tr_b16 v[70:71], v2 offset:23296
    v_mfma_f32_32x32x16_bf16 v[32:47], v[64:67], v[76:79], v[32:47]
    ds_read_b128 v[84:87], v109 offset:0
    ds_read_b128 v[88:91], v109 offset:4096
    s_add_u32 m0, s33, 16384
    s_nop 0
    buffer_load_dwordx4 v104, s[8:11], s20 offen lds
    v_mfma_f32_32x32x16_bf16 v[48:63], v[64:67], v[80:83], v[48:63]
    ds_read_b128 v[92:95], v109 offset:8192
    s_add_u32 m0, s33, 20480
    s_nop 0
    buffer_load_dwordx4 v105, s[8:11], s20 offen lds
    s_add_u32 s20, s20, 128
    s_waitcnt vmcnt(0) lgkmcnt(0)
    s_barrier
    v_mfma_f32_32x32x16_bf16 v[16:31], v[68:71], v[84:87], v[16:31]
    ds_read_b64_tr_b16 v[64:65], v2 offset:28672
    ds_read_b64_tr_b16 v[66:67], v2 offset:30464
    s_add_u32 m0, s32, 0
    s_nop 0
    buffer_load_dwordx4 v96, s[12:15], s30 offen lds
    v_mfma_f32_32x32x16_bf16 v[32:47], v[68:71], v[88:91], v[32:47]
    ds_read_b128 v[72:75], v106 offset:12288
    ds_read_b128 v[76:79], v106 offset:16384
    s_add_u32 m0, s32, 1024
    s_nop 0
    buffer_load_dwordx4 v97, s[12:15], s30 offen lds
    v_mfma_f32_32x32x16_bf16 v[48:63], v[68:71], v[92:95], v[48:63]
    ds_read_b128 v[80:83], v106 offset:20480
    s_add_u32 m0, s32, 2048
    s_nop 0
    buffer_load_dwordx4 v98, s[12:15], s30 offen lds
    s_waitcnt lgkmcnt(0)
    v_mfma_f32_32x32x16_bf16 v[16:31], v[64:67], v[72:75], v[16:31]
    ds_read_b64_tr_b16 v[68:69], v2 offset:35840
    ds_read_b64_tr_b16 v[70:71], v2 offset:37632
    s_add_u32 m0, s32, 3072
    s_nop 0
    buffer_load_dwordx4 v99, s[12:15], s30 offen lds
    v_mfma_f32_32x32x16_bf16 v[32:47], v[64:67], v[76:79], v[32:47]
    ds_read_b128 v[84:87], v107 offset:12288
    ds_read_b128 v[88:91], v107 offset:16384
    s_add_u32 m0, s32, 4096
    s_nop 0
    buffer_load_dwordx4 v100, s[12:15], s30 offen lds
    v_mfma_f32_32x32x16_bf16 v[48:63], v[64:67], v[80:83], v[48:63]
    ds_read_b128 v[92:95], v107 offset:20480
    s_add_u32 m0, s32, 5120
    s_nop 0
    buffer_load_dwordx4 v101, s[12:15], s30 offen lds
    s_waitcnt lgkmcnt(0)
    v_mfma_f32_32x32x16_bf16 v[16:31], v[68:71], v[84:87], v[16:31]
    ds_read_b64_tr_b16 v[64:65], v2 offset:43008
    ds_read_b64_tr_b16 v[66:67], v2 offset:44800
    v_mfma_f32_32x32x16_bf16 v[32:47], v[68:71], v[88:91], v[32:47]
    ds_read_b128 v[72:75], v108 offset:12288
    ds_read_b128 v[76:79], v108 offset:16384
    s_add_u32 m0, s32, 6144
    s_nop 0
    buffer_load_dwordx4 v102, s[12:15], s30 offen lds
    s_add_u32 s30, s30, s31
    v_mfma_f32_32x32x16_bf16 v[48:63], v[68:71], v[92:95], v[48:63]
    ds_read_b128 v[80:83], v108 offset:20480
    s_add_u32 m0, s33, 0
    s_nop 0
    buffer_load_dwordx4 v103, s[8:11], s20 offen lds
    s_waitcnt lgkmcnt(0)
    v_mfma_f32_32x32x16_bf16 v[16:31], v[64:67], v[72:75], v[16:31]
    ds_read_b64_tr_b16 v[68:69], v2 offset:50176
    ds_read_b64_tr_b16 v[70:71], v2 offset:51968
    v_mfma_f32_32x32x16_bf16 v[32:47], v[64:67], v[76:79], v[32:47]
    ds_read_b128 v[84:87], v109 offset:12288
    ds_read_b128 v[88:91], v109 offset:16384
    s_add_u32 m0, s33, 4096
    s_nop 0
    buffer_load_dwordx4 v104, s[8:11], s20 offen lds
    v_mfma_f32_32x32x16_bf16 v[48:63], v[64:67], v[80:83], v[48:63]
    ds_read_b128 v[92:95], v109 offset:20480
    s_add_u32 m0, s33, 8192
    s_nop 0
    buffer_load_dwordx4 v105, s[8:11], s20 offen lds
    s_add_u32 s20, s20, 128
    s_waitcnt vmcnt(0) lgkmcnt(0)
    s_barrier
    v_mfma_f32_32x32x16_bf16 v[16:31], v[68:71], v[84:87], v[16:31]
    ds_read_b64_tr_b16 v[64:65], v2 offset:0
    ds_read_b64_tr_b16 v[66:67], v2 offset:1792
    v_mfma_f32_32x32x16_bf16 v[32:47], v[68:71], v[88:91], v[32:47]
    ds_read_b128 v[72:75], v106 offset:0
    ds_read_b128 v[76:79], v106 offset:4096
    v_mfma_f32_32x32x16_bf16 v[48:63], v[68:71], v[92:95], v[48:63]
    ds_read_b128 v[80:83], v106 offset:8192
    s_waitcnt lgkmcnt(0)
    v_mfma_f32_32x32x16_bf16 v[16:31], v[64:67], v[72:75], v[16:31]
    ds_read_b64_tr_b16 v[68:69], v2 offset:7168
    ds_read_b64_tr_b16 v[70:71], v2 offset:8960
    v_mfma_f32_32x32x16_bf16 v[32:47], v[64:67], v[76:79], v[32:47]
    ds_read_b128 v[84:87], v107 offset:0
    ds_read_b128 v[88:91], v107 offset:4096
    v_mfma_f32_32x32x16_bf16 v[48:63], v[64:67], v[80:83], v[48:63]
    ds_read_b128 v[92:95], v107 offset:8192
    s_waitcnt lgkmcnt(0)
    v_mfma_f32_32x32x16_bf16 v[16:31], v[68:71], v[84:87], v[16:31]
    ds_read_b64_tr_b16 v[64:65], v2 offset:14336
    ds_read_b64_tr_b16 v[66:67], v2 offset:16128
    v_mfma_f32_32x32x16_bf16 v[32:47], v[68:71], v[88:91], v[32:47]
    ds_read_b128 v[72:75], v108 offset:0
    ds_read_b128 v[76:79], v108 offset:4096
    v_mfma_f32_32x32x16_bf16 v[48:63], v[68:71], v[92:95], v[48:63]
    ds_read_b128 v[80:83], v108 offset:8192
    s_waitcnt lgkmcnt(0)
    v_mfma_f32_32x32x16_bf16 v[16:31], v[64:67], v[72:75], v[16:31]
    ds_read_b64_tr_b16 v[68:69], v2 offset:21504
    ds_read_b64_tr_b16 v[70:71], v2 offset:23296
    v_mfma_f32_32x32x16_bf16 v[32:47], v[64:67], v[76:79], v[32:47]
    ds_read_b128 v[84:87], v109 offset:0
    ds_read_b128 v[88:91], v109 offset:4096
    v_mfma_f32_32x32x16_bf16 v[48:63], v[64:67], v[80:83], v[48:63]
    ds_read_b128 v[92:95], v109 offset:8192
    s_waitcnt lgkmcnt(0)
    v_mfma_f32_32x32x16_bf16 v[16:31], v[68:71], v[84:87], v[16:31]
    v_mfma_f32_32x32x16_bf16 v[32:47], v[68:71], v[88:91], v[32:47]
    v_mfma_f32_32x32x16_bf16 v[48:63], v[68:71], v[92:95], v[48:63]
    s_barrier
    s_mov_b32 s28, 0x3eae1a93
    s_nop 12
    v_cvt_pk_bf16_f32 v64, v16, v17
    v_cvt_pk_bf16_f32 v65, v18, v19
    v_cvt_pk_bf16_f32 v66, v20, v21
    v_cvt_pk_bf16_f32 v67, v22, v23
    v_cvt_pk_bf16_f32 v68, v24, v25
    v_cvt_pk_bf16_f32 v69, v26, v27
    v_cvt_pk_bf16_f32 v70, v28, v29
    v_cvt_pk_bf16_f32 v71, v30, v31
    s_nop 1
    v_permlane32_swap_b32 v64, v66
    v_permlane32_swap_b32 v65, v67
    v_permlane32_swap_b32 v68, v70
    v_permlane32_swap_b32 v69, v71
    ds_write_b128 v114, v[64:67] offset:0
    ds_write_b128 v114, v[68:71] offset:32
    v_cvt_pk_bf16_f32 v72, v32, v33
    v_cvt_pk_bf16_f32 v73, v34, v35
    v_cvt_pk_bf16_f32 v74, v36, v37
    v_cvt_pk_bf16_f32 v75, v38, v39
    v_cvt_pk_bf16_f32 v76, v40, v41
    v_cvt_pk_bf16_f32 v77, v42, v43
    v_cvt_pk_bf16_f32 v78, v44, v45
    v_cvt_pk_bf16_f32 v79, v46, v47
    s_nop 1
    v_permlane32_swap_b32 v72, v74
    v_permlane32_swap_b32 v73, v75
    v_permlane32_swap_b32 v76, v78
    v_permlane32_swap_b32 v77, v79
    ds_write_b128 v114, v[72:75] offset:14848
    ds_write_b128 v114, v[76:79] offset:14880
    v_cvt_pk_bf16_f32 v64, v48, v49
    v_cvt_pk_bf16_f32 v65, v50, v51
    v_cvt_pk_bf16_f32 v66, v52, v53
    v_cvt_pk_bf16_f32 v67, v54, v55
    v_cvt_pk_bf16_f32 v68, v56, v57
    v_cvt_pk_bf16_f32 v69, v58, v59
    v_cvt_pk_bf16_f32 v70, v60, v61
    v_cvt_pk_bf16_f32 v71, v62, v63
    s_nop 1
    v_permlane32_swap_b32 v64, v66
    v_permlane32_swap_b32 v65, v67
    v_permlane32_swap_b32 v68, v70
    v_permlane32_swap_b32 v69, v71
    ds_write_b128 v114, v[64:67] offset:29696
    ds_write_b128 v114, v[68:71] offset:29728
    s_waitcnt lgkmcnt(0)
    s_branch L_ar_fin
L_ar_w4:
    s_waitcnt lgkmcnt(0)
    s_mov_b32 s8, s40
    s_mov_b32 s9, s41
    s_mov_b32 s10, 2359296
    s_mov_b32 s11, 0x00020000
    s_mov_b32 s12, s42
    s_mov_b32 s13, s43
    s_mov_b32 s14, 1990656
    s_mov_b32 s15, 0x00020000
    s_mov_b32 s16, s56
    s_mov_b32 s17, s57
    s_mov_b32 s18, 16777216
    s_mov_b32 s19, 0x00020000
    s_cmp_ge_u32 s27, 7
    s_cbranch_scc1 L_ar_idle
    v_and_b32 v1, 63, v0
    s_mov_b32 s34, 0
    s_mov_b32 s35, s27
    v_lshrrev_b32 v6, 5, v1
    v_lshlrev_b32 v6, 3, v6
    v_bfe_u32 v7, v1, 2, 2
    v_add_u32 v6, v6, v7
    v_mul_u32_u24 v6, 448, v6
    v_bfe_u32 v7, v1, 4, 1
    v_lshlrev_b32 v7, 5, v7
    v_and_b32 v8, 3, v1
    v_lshlrev_b32 v8, 3, v8
    v_add3_u32 v2, v6, v7, v8
    s_mul_i32 s28, s35, 64
    v_add_u32 v2, s28, v2
    v_add_u32 v3, 57344, v2
    v_add_u32 v4, 114688, v2
    v_add_u32 v5, 172032, v2
    v_and_b32 v6, 31, v1
    v_lshrrev_b32 v7, 5, v1
    v_bfe_u32 v8, v1, 1, 3
    v_lshlrev_b32 v10, 7, v6
    s_mul_i32 s28, s34, 12288
    s_add_u32 s28, s28, 57344
    v_add_u32 v10, s28, v10
    v_add_u32 v9, 0, v7
    v_xor_b32 v9, v9, v8
    v_lshl_add_u32 v106, v9, 4, v10
    v_add_u32 v9, 2, v7
    v_xor_b32 v9, v9, v8
    v_lshl_add_u32 v107, v9, 4, v10
    v_add_u32 v9, 4, v7
    v_xor_b32 v9, v9, v8
    v_lshl_add_u32 v108, v9, 4, v10
    v_add_u32 v9, 6, v7
    v_xor_b32 v9, v9, v8
    v_lshl_add_u32 v109, v9, 4, v10
    s_mul_i32 s28, s34, 44544
    s_mul_i32 s29, s35, 64
    s_add_u32 s28, s28, s29
    v_mul_u32_u24 v6, 464, v6
    v_lshl_add_u32 v6, v7, 4, v6
    v_add_u32 v114, s28, v6
    s_waitcnt lgkmcnt(0)
    s_barrier
    ds_read_b64_tr_b16 v[64:65], v2 offset:0
    ds_read_b64_tr_b16 v[66:67], v2 offset:1792
    ds_read_b128 v[72:75], v106 offset:0
    ds_read_b128 v[76:79], v106 offset:4096
    ds_read_b128 v[80:83], v106 offset:8192
    s_waitcnt lgkmcnt(0)
    v_mfma_f32_32x32x16_bf16 v[16:31], v[64:67], v[72:75], 0
    ds_read_b64_tr_b16 v[68:69], v2 offset:7168
    ds_read_b64_tr_b16 v[70:71], v2 offset:8960
    v_mfma_f32_32x32x16_bf16 v[32:47], v[64:67], v[76:79], 0
    ds_read_b128 v[84:87], v107 offset:0
    ds_read_b128 v[88:91], v107 offset:4096
    v_mfma_f32_32x32x16_bf16 v[48:63], v[64:67], v[80:83], 0
    ds_read_b128 v[92:95], v107 offset:8192
    s_waitcnt lgkmcnt(0)
    v_mfma_f32_32x32x16_bf16 v[16:31], v[68:71], v[84:87], v[16:31]
    ds_read_b64_tr_b16 v[64:65], v2 offset:14336
    ds_read_b64_tr_b16 v[66:67], v2 offset:16128
    v_mfma_f32_32x32x16_bf16 v[32:47], v[68:71], v[88:91], v[32:47]
    ds_read_b128 v[72:75], v108 offset:0
    ds_read_b128 v[76:79], v108 offset:4096
    v_mfma_f32_32x32x16_bf16 v[48:63], v[68:71], v[92:95], v[48:63]
    ds_read_b128 v[80:83], v108 offset:8192
    s_waitcnt lgkmcnt(0)
    v_mfma_f32_32x32x16_bf16 v[16:31], v[64:67], v[72:75], v[16:31]
    ds_read_b64_tr_b16 v[68:69], v2 offset:21504
    ds_read_b64_tr_b16 v[70:71], v2 offset:23296
    v_mfma_f32_32x32x16_bf16 v[32:47], v[64:67], v[76:79], v[32:47]
    ds_read_b128 v[84:87], v109 offset:0
    ds_read_b128 v[88:91], v109 offset:4096
    v_mfma_f32_32x32x16_bf16 v[48:63], v[64:67], v[80:83], v[48:63]
    ds_read_b128 v[92:95], v109 offset:8192
    s_waitcnt lgkmcnt(0)
    s_barrier
    v_mfma_f32_32x32x16_bf16 v[16:31], v[68:71], v[84:87], v[16:31]
    ds_read_b64_tr_b16 v[64:65], v2 offset:28672
    ds_read_b64_tr_b16 v[66:67], v2 offset:30464
    v_mfma_f32_32x32x16_bf16 v[32:47], v[68:71], v[88:91], v[32:47]
    ds_read_b128 v[72:75], v106 offset:12288
    ds_read_b128 v[76:79], v106 offset:16384
    v_mfma_f32_32x32x16_bf16 v[48:63], v[68:71], v[92:95], v[48:63]
    ds_read_b128 v[80:83], v106 offset:20480
    s_waitcnt lgkmcnt(0)
    v_mfma_f32_32x32x16_bf16 v[16:31], v[64:67], v[72:75], v[16:31]
    ds_read_b64_tr_b16 v[68:69], v2 offset:35840
    ds_read_b64_tr_b16 v[70:71], v2 offset:37632
    v_mfma_f32_32x32x16_bf16 v[32:47], v[64:67], v[76:79], v[32:47]
    ds_read_b128 v[84:87], v107 offset:12288
    ds_read_b128 v[88:91], v107 offset:16384
    v_mfma_f32_32x32x16_bf16 v[48:63], v[64:67], v[80:83], v[48:63]
    ds_read_b128 v[92:95], v107 offset:20480
    s_waitcnt lgkmcnt(0)
    v_mfma_f32_32x32x16_bf16 v[16:31], v[68:71], v[84:87], v[16:31]
    ds_read_b64_tr_b16 v[64:65], v2 offset:43008
    ds_read_b64_tr_b16 v[66:67], v2 offset:44800
    v_mfma_f32_32x32x16_bf16 v[32:47], v[68:71], v[88:91], v[32:47]
    ds_read_b128 v[72:75], v108 offset:12288
    ds_read_b128 v[76:79], v108 offset:16384
    v_mfma_f32_32x32x16_bf16 v[48:63], v[68:71], v[92:95], v[48:63]
    ds_read_b128 v[80:83], v108 offset:20480
    s_waitcnt lgkmcnt(0)
    v_mfma_f32_32x32x16_bf16 v[16:31], v[64:67], v[72:75], v[16:31]
    ds_read_b64_tr_b16 v[68:69], v2 offset:50176
    ds_read_b64_tr_b16 v[70:71], v2 offset:51968
    v_mfma_f32_32x32x16_bf16 v[32:47], v[64:67], v[76:79], v[32:47]
    ds_read_b128 v[84:87], v109 offset:12288
    ds_read_b128 v[88:91], v109 offset:16384
    v_mfma_f32_32x32x16_bf16 v[48:63], v[64:67], v[80:83], v[48:63]
    ds_read_b128 v[92:95], v109 offset:20480
    s_waitcnt lgkmcnt(0)
    s_barrier
    v_mfma_f32_32x32x16_bf16 v[16:31], v[68:71], v[84:87], v[16:31]
    ds_read_b64_tr_b16 v[64:65], v2 offset:0
    ds_read_b64_tr_b16 v[66:67], v2 offset:1792
    v_mfma_f32_32x32x16_bf16 v[32:47], v[68:71], v[88:91], v[32:47]
    ds_read_b128 v[72:75], v106 offset:0
    ds_read_b128 v[76:79], v106 offset:4096
    v_mfma_f32_32x32x16_bf16 v[48:63], v[68:71], v[92:95], v[48:63]
    ds_read_b128 v[80:83], v106 offset:8192
    s_waitcnt lgkmcnt(0)
    v_mfma_f32_32x32x16_bf16 v[16:31], v[64:67], v[72:75], v[16:31]
    ds_read_b64_tr_b16 v[68:69], v2 offset:7168
    ds_read_b64_tr_b16 v[70:71], v2 offset:8960
    v_mfma_f32_32x32x16_bf16 v[32:47], v[64:67], v[76:79], v[32:47]
    ds_read_b128 v[84:87], v107 offset:0
    ds_read_b128 v[88:91], v107 offset:4096
    v_mfma_f32_32x32x16_bf16 v[48:63], v[64:67], v[80:83], v[48:63]
    ds_read_b128 v[92:95], v107 offset:8192
    s_waitcnt lgkmcnt(0)
    v_mfma_f32_32x32x16_bf16 v[16:31], v[68:71], v[84:87], v[16:31]
    ds_read_b64_tr_b16 v[64:65], v2 offset:14336
    ds_read_b64_tr_b16 v[66:67], v2 offset:16128
    v_mfma_f32_32x32x16_bf16 v[32:47], v[68:71], v[88:91], v[32:47]
    ds_read_b128 v[72:75], v108 offset:0
    ds_read_b128 v[76:79], v108 offset:4096
    v_mfma_f32_32x32x16_bf16 v[48:63], v[68:71], v[92:95], v[48:63]
    ds_read_b128 v[80:83], v108 offset:8192
    s_waitcnt lgkmcnt(0)
    v_mfma_f32_32x32x16_bf16 v[16:31], v[64:67], v[72:75], v[16:31]
    ds_read_b64_tr_b16 v[68:69], v2 offset:21504
    ds_read_b64_tr_b16 v[70:71], v2 offset:23296
    v_mfma_f32_32x32x16_bf16 v[32:47], v[64:67], v[76:79], v[32:47]
    ds_read_b128 v[84:87], v109 offset:0
    ds_read_b128 v[88:91], v109 offset:4096
    v_mfma_f32_32x32x16_bf16 v[48:63], v[64:67], v[80:83], v[48:63]
    ds_read_b128 v[92:95], v109 offset:8192
    s_waitcnt lgkmcnt(0)
    s_barrier
    v_mfma_f32_32x32x16_bf16 v[16:31], v[68:71], v[84:87], v[16:31]
    ds_read_b64_tr_b16 v[64:65], v2 offset:28672
    ds_read_b64_tr_b16 v[66:67], v2 offset:30464
    v_mfma_f32_32x32x16_bf16 v[32:47], v[68:71], v[88:91], v[32:47]
    ds_read_b128 v[72:75], v106 offset:12288
    ds_read_b128 v[76:79], v106 offset:16384
    v_mfma_f32_32x32x16_bf16 v[48:63], v[68:71], v[92:95], v[48:63]
    ds_read_b128 v[80:83], v106 offset:20480
    s_waitcnt lgkmcnt(0)
    v_mfma_f32_32x32x16_bf16 v[16:31], v[64:67], v[72:75], v[16:31]
    ds_read_b64_tr_b16 v[68:69], v2 offset:35840
    ds_read_b64_tr_b16 v[70:71], v2 offset:37632
    v_mfma_f32_32x32x16_bf16 v[32:47], v[64:67], v[76:79], v[32:47]
    ds_read_b128 v[84:87], v107 offset:12288
    ds_read_b128 v[88:91], v107 offset:16384
    v_mfma_f32_32x32x16_bf16 v[48:63], v[64:67], v[80:83], v[48:63]
    ds_read_b128 v[92:95], v107 offset:20480
    s_waitcnt lgkmcnt(0)
    v_mfma_f32_32x32x16_bf16 v[16:31], v[68:71], v[84:87], v[16:31]
    ds_read_b64_tr_b16 v[64:65], v2 offset:43008
    ds_read_b64_tr_b16 v[66:67], v2 offset:44800
    v_mfma_f32_32x32x16_bf16 v[32:47], v[68:71], v[88:91], v[32:47]
    ds_read_b128 v[72:75], v108 offset:12288
    ds_read_b128 v[76:79], v108 offset:16384
    v_mfma_f32_32x32x16_bf16 v[48:63], v[68:71], v[92:95], v[48:63]
    ds_read_b128 v[80:83], v108 offset:20480
    s_waitcnt lgkmcnt(0)
    v_mfma_f32_32x32x16_bf16 v[16:31], v[64:67], v[72:75], v[16:31]
    ds_read_b64_tr_b16 v[68:69], v2 offset:50176
    ds_read_b64_tr_b16 v[70:71], v2 offset:51968
    v_mfma_f32_32x32x16_bf16 v[32:47], v[64:67], v[76:79], v[32:47]
    ds_read_b128 v[84:87], v109 offset:12288
    ds_read_b128 v[88:91], v109 offset:16384
    v_mfma_f32_32x32x16_bf16 v[48:63], v[64:67], v[80:83], v[48:63]
    ds_read_b128 v[92:95], v109 offset:20480
    s_waitcnt lgkmcnt(0)
    s_barrier
    v_mfma_f32_32x32x16_bf16 v[16:31], v[68:71], v[84:87], v[16:31]
    ds_read_b64_tr_b16 v[64:65], v2 offset:0
    ds_read_b64_tr_b16 v[66:67], v2 offset:1792
    v_mfma_f32_32x32x16_bf16 v[32:47], v[68:71], v[88:91], v[32:47]
    ds_read_b128 v[72:75], v106 offset:0
    ds_read_b128 v[76:79], v106 offset:4096
    v_mfma_f32_32x32x16_bf16 v[48:63], v[68:71], v[92:95], v[48:63]
    ds_read_b128 v[80:83], v106 offset:8192
    s_waitcnt lgkmcnt(0)
    v_mfma_f32_32x32x16_bf16 v[16:31], v[64:67], v[72:75], v[16:31]
    ds_read_b64_tr_b16 v[68:69], v2 offset:7168
    ds_read_b64_tr_b16 v[70:71], v2 offset:8960
    v_mfma_f32_32x32x16_bf16 v[32:47], v[64:67], v[76:79], v[32:47]
    ds_read_b128 v[84:87], v107 offset:0
    ds_read_b128 v[88:91], v107 offset:4096
    v_mfma_f32_32x32x16_bf16 v[48:63], v[64:67], v[80:83], v[48:63]
    ds_read_b128 v[92:95], v107 offset:8192
    s_waitcnt lgkmcnt(0)
    v_mfma_f32_32x32x16_bf16 v[16:31], v[68:71], v[84:87], v[16:31]
    ds_read_b64_tr_b16 v[64:65], v2 offset:14336
    ds_read_b64_tr_b16 v[66:67], v2 offset:16128
    v_mfma_f32_32x32x16_bf16 v[32:47], v[68:71], v[88:91], v[32:47]
    ds_read_b128 v[72:75], v108 offset:0
    ds_read_b128 v[76:79], v108 offset:4096
    v_mfma_f32_32x32x16_bf16 v[48:63], v[68:71], v[92:95], v[48:63]
    ds_read_b128 v[80:83], v108 offset:8192
    s_waitcnt lgkmcnt(0)
    v_mfma_f32_32x32x16_bf16 v[16:31], v[64:67], v[72:75], v[16:31]
    ds_read_b64_tr_b16 v[68:69], v2 offset:21504
    ds_read_b64_tr_b16 v[70:71], v2 offset:23296
    v_mfma_f32_32x32x16_bf16 v[32:47], v[64:67], v[76:79], v[32:47]
    ds_read_b128 v[84:87], v109 offset:0
    ds_read_b128 v[88:91], v109 offset:4096
    v_mfma_f32_32x32x16_bf16 v[48:63], v[64:67], v[80:83], v[48:63]
    ds_read_b128 v[92:95], v109 offset:8192
    s_waitcnt lgkmcnt(0)
    s_barrier
    v_mfma_f32_32x32x16_bf16 v[16:31], v[68:71], v[84:87], v[16:31]
    ds_read_b64_tr_b16 v[64:65], v2 offset:28672
    ds_read_b64_tr_b16 v[66:67], v2 offset:30464
    v_mfma_f32_32x32x16_bf16 v[32:47], v[68:71], v[88:91], v[32:47]
    ds_read_b128 v[72:75], v106 offset:12288
    ds_read_b128 v[76:79], v106 offset:16384
    v_mfma_f32_32x32x16_bf16 v[48:63], v[68:71], v[92:95], v[48:63]
    ds_read_b128 v[80:83], v106 offset:20480
    s_waitcnt lgkmcnt(0)
    v_mfma_f32_32x32x16_bf16 v[16:31], v[64:67], v[72:75], v[16:31]
    ds_read_b64_tr_b16 v[68:69], v2 offset:35840
    ds_read_b64_tr_b16 v[70:71], v2 offset:37632
    v_mfma_f32_32x32x16_bf16 v[32:47], v[64:67], v[76:79], v[32:47]
    ds_read_b128 v[84:87], v107 offset:12288
    ds_read_b128 v[88:91], v107 offset:16384
    v_mfma_f32_32x32x16_bf16 v[48:63], v[64:67], v[80:83], v[48:63]
    ds_read_b128 v[92:95], v107 offset:20480
    s_waitcnt lgkmcnt(0)
    v_mfma_f32_32x32x16_bf16 v[16:31], v[68:71], v[84:87], v[16:31]
    ds_read_b64_tr_b16 v[64:65], v2 offset:43008
    ds_read_b64_tr_b16 v[66:67], v2 offset:44800
    v_mfma_f32_32x32x16_bf16 v[32:47], v[68:71], v[88:91], v[32:47]
    ds_read_b128 v[72:75], v108 offset:12288
    ds_read_b128 v[76:79], v108 offset:16384
    v_mfma_f32_32x32x16_bf16 v[48:63], v[68:71], v[92:95], v[48:63]
    ds_read_b128 v[80:83], v108 offset:20480
    s_waitcnt lgkmcnt(0)
    v_mfma_f32_32x32x16_bf16 v[16:31], v[64:67], v[72:75], v[16:31]
    ds_read_b64_tr_b16 v[68:69], v2 offset:50176
    ds_read_b64_tr_b16 v[70:71], v2 offset:51968
    v_mfma_f32_32x32x16_bf16 v[32:47], v[64:67], v[76:79], v[32:47]
    ds_read_b128 v[84:87], v109 offset:12288
    ds_read_b128 v[88:91], v109 offset:16384
    v_mfma_f32_32x32x16_bf16 v[48:63], v[64:67], v[80:83], v[48:63]
    ds_read_b128 v[92:95], v109 offset:20480
    s_waitcnt lgkmcnt(0)
    s_barrier
    v_mfma_f32_32x32x16_bf16 v[16:31], v[68:71], v[84:87], v[16:31]
    ds_read_b64_tr_b16 v[64:65], v2 offset:0
    ds_read_b64_tr_b16 v[66:67], v2 offset:1792
    v_mfma_f32_32x32x16_bf16 v[32:47], v[68:71], v[88:91], v[32:47]
    ds_read_b128 v[72:75], v106 offset:0
    ds_read_b128 v[76:79], v106 offset:4096
    v_mfma_f32_32x32x16_bf16 v[48:63], v[68:71], v[92:95], v[48:63]
    ds_read_b128 v[80:83], v106 offset:8192
    s_waitcnt lgkmcnt(0)
    v_mfma_f32_32x32x16_bf16 v[16:31], v[64:67], v[72:75], v[16:31]
    ds_read_b64_tr_b16 v[68:69], v2 offset:7168
    ds_read_b64_tr_b16 v[70:71], v2 offset:8960
    v_mfma_f32_32x32x16_bf16 v[32:47], v[64:67], v[76:79], v[32:47]
    ds_read_b128 v[84:87], v107 offset:0
    ds_read_b128 v[88:91], v107 offset:4096
    v_mfma_f32_32x32x16_bf16 v[48:63], v[64:67], v[80:83], v[48:63]
    ds_read_b128 v[92:95], v107 offset:8192
    s_waitcnt lgkmcnt(0)
    v_mfma_f32_32x32x16_bf16 v[16:31], v[68:71], v[84:87], v[16:31]
    ds_read_b64_tr_b16 v[64:65], v2 offset:14336
    ds_read_b64_tr_b16 v[66:67], v2 offset:16128
    v_mfma_f32_32x32x16_bf16 v[32:47], v[68:71], v[88:91], v[32:47]
    ds_read_b128 v[72:75], v108 offset:0
    ds_read_b128 v[76:79], v108 offset:4096
    v_mfma_f32_32x32x16_bf16 v[48:63], v[68:71], v[92:95], v[48:63]
    ds_read_b128 v[80:83], v108 offset:8192
    s_waitcnt lgkmcnt(0)
    v_mfma_f32_32x32x16_bf16 v[16:31], v[64:67], v[72:75], v[16:31]
    ds_read_b64_tr_b16 v[68:69], v2 offset:21504
    ds_read_b64_tr_b16 v[70:71], v2 offset:23296
    v_mfma_f32_32x32x16_bf16 v[32:47], v[64:67], v[76:79], v[32:47]
    ds_read_b128 v[84:87], v109 offset:0
    ds_read_b128 v[88:91], v109 offset:4096
    v_mfma_f32_32x32x16_bf16 v[48:63], v[64:67], v[80:83], v[48:63]
    ds_read_b128 v[92:95], v109 offset:8192
    s_waitcnt lgkmcnt(0)
    s_barrier
    v_mfma_f32_32x32x16_bf16 v[16:31], v[68:71], v[84:87], v[16:31]
    ds_read_b64_tr_b16 v[64:65], v2 offset:28672
    ds_read_b64_tr_b16 v[66:67], v2 offset:30464
    v_mfma_f32_32x32x16_bf16 v[32:47], v[68:71], v[88:91], v[32:47]
    ds_read_b128 v[72:75], v106 offset:12288
    ds_read_b128 v[76:79], v106 offset:16384
    v_mfma_f32_32x32x16_bf16 v[48:63], v[68:71], v[92:95], v[48:63]
    ds_read_b128 v[80:83], v106 offset:20480
    s_waitcnt lgkmcnt(0)
    v_mfma_f32_32x32x16_bf16 v[16:31], v[64:67], v[72:75], v[16:31]
    ds_read_b64_tr_b16 v[68:69], v2 offset:35840
    ds_read_b64_tr_b16 v[70:71], v2 offset:37632
    v_mfma_f32_32x32x16_bf16 v[32:47], v[64:67], v[76:79], v[32:47]
    ds_read_b128 v[84:87], v107 offset:12288
    ds_read_b128 v[88:91], v107 offset:16384
    v_mfma_f32_32x32x16_bf16 v[48:63], v[64:67], v[80:83], v[48:63]
    ds_read_b128 v[92:95], v107 offset:20480
    s_waitcnt lgkmcnt(0)
    v_mfma_f32_32x32x16_bf16 v[16:31], v[68:71], v[84:87], v[16:31]
    ds_read_b64_tr_b16 v[64:65], v2 offset:43008
    ds_read_b64_tr_b16 v[66:67], v2 offset:44800
    v_mfma_f32_32x32x16_bf16 v[32:47], v[68:71], v[88:91], v[32:47]
    ds_read_b128 v[72:75], v108 offset:12288
    ds_read_b128 v[76:79], v108 offset:16384
    v_mfma_f32_32x32x16_bf16 v[48:63], v[68:71], v[92:95], v[48:63]
    ds_read_b128 v[80:83], v108 offset:20480
    s_waitcnt lgkmcnt(0)
    v_mfma_f32_32x32x16_bf16 v[16:31], v[64:67], v[72:75], v[16:31]
    ds_read_b64_tr_b16 v[68:69], v2 offset:50176
    ds_read_b64_tr_b16 v[70:71], v2 offset:51968
    v_mfma_f32_32x32x16_bf16 v[32:47], v[64:67], v[76:79], v[32:47]
    ds_read_b128 v[84:87], v109 offset:12288
    ds_read_b128 v[88:91], v109 offset:16384
    v_mfma_f32_32x32x16_bf16 v[48:63], v[64:67], v[80:83], v[48:63]
    ds_read_b128 v[92:95], v109 offset:20480
    s_waitcnt lgkmcnt(0)
    s_barrier
    v_mfma_f32_32x32x16_bf16 v[16:31], v[68:71], v[84:87], v[16:31]
    ds_read_b64_tr_b16 v[64:65], v2 offset:0
    ds_read_b64_tr_b16 v[66:67], v2 offset:1792
    v_mfma_f32_32x32x16_bf16 v[32:47], v[68:71], v[88:91], v[32:47]
    ds_read_b128 v[72:75], v106 offset:0
    ds_read_b128 v[76:79], v106 offset:4096
    v_mfma_f32_32x32x16_bf16 v[48:63], v[68:71], v[92:95], v[48:63]
    ds_read_b128 v[80:83], v106 offset:8192
    s_waitcnt lgkmcnt(0)
    v_mfma_f32_32x32x16_bf16 v[16:31], v[64:67], v[72:75], v[16:31]
    ds_read_b64_tr_b16 v[68:69], v2 offset:7168
    ds_read_b64_tr_b16 v[70:71], v2 offset:8960
    v_mfma_f32_32x32x16_bf16 v[32:47], v[64:67], v[76:79], v[32:47]
    ds_read_b128 v[84:87], v107 offset:0
    ds_read_b128 v[88:91], v107 offset:4096
    v_mfma_f32_32x32x16_bf16 v[48:63], v[64:67], v[80:83], v[48:63]
    ds_read_b128 v[92:95], v107 offset:8192
    s_waitcnt lgkmcnt(0)
    v_mfma_f32_32x32x16_bf16 v[16:31], v[68:71], v[84:87], v[16:31]
    ds_read_b64_tr_b16 v[64:65], v2 offset:14336
    ds_read_b64_tr_b16 v[66:67], v2 offset:16128
    v_mfma_f32_32x32x16_bf16 v[32:47], v[68:71], v[88:91], v[32:47]
    ds_read_b128 v[72:75], v108 offset:0
    ds_read_b128 v[76:79], v108 offset:4096
    v_mfma_f32_32x32x16_bf16 v[48:63], v[68:71], v[92:95], v[48:63]
    ds_read_b128 v[80:83], v108 offset:8192
    s_waitcnt lgkmcnt(0)
    v_mfma_f32_32x32x16_bf16 v[16:31], v[64:67], v[72:75], v[16:31]
    ds_read_b64_tr_b16 v[68:69], v2 offset:21504
    ds_read_b64_tr_b16 v[70:71], v2 offset:23296
    v_mfma_f32_32x32x16_bf16 v[32:47], v[64:67], v[76:79], v[32:47]
    ds_read_b128 v[84:87], v109 offset:0
    ds_read_b128 v[88:91], v109 offset:4096
    v_mfma_f32_32x32x16_bf16 v[48:63], v[64:67], v[80:83], v[48:63]
    ds_read_b128 v[92:95], v109 offset:8192
    s_waitcnt lgkmcnt(0)
    v_mfma_f32_32x32x16_bf16 v[16:31], v[68:71], v[84:87], v[16:31]
    v_mfma_f32_32x32x16_bf16 v[32:47], v[68:71], v[88:91], v[32:47]
    v_mfma_f32_32x32x16_bf16 v[48:63], v[68:71], v[92:95], v[48:63]
    s_barrier
    s_mov_b32 s28, 0x3eae1a93
    s_nop 12
    v_cvt_pk_bf16_f32 v64, v16, v17
    v_cvt_pk_bf16_f32 v65, v18, v19
    v_cvt_pk_bf16_f32 v66, v20, v21
    v_cvt_pk_bf16_f32 v67, v22, v23
    v_cvt_pk_bf16_f32 v68, v24, v25
    v_cvt_pk_bf16_f32 v69, v26, v27
    v_cvt_pk_bf16_f32 v70, v28, v29
    v_cvt_pk_bf16_f32 v71, v30, v31
    s_nop 1
    v_permlane32_swap_b32 v64, v66
    v_permlane32_swap_b32 v65, v67
    v_permlane32_swap_b32 v68, v70
    v_permlane32_swap_b32 v69, v71
    ds_write_b128 v114, v[64:67] offset:0
    ds_write_b128 v114, v[68:71] offset:32
    v_cvt_pk_bf16_f32 v72, v32, v33
    v_cvt_pk_bf16_f32 v73, v34, v35
    v_cvt_pk_bf16_f32 v74, v36, v37
    v_cvt_pk_bf16_f32 v75, v38, v39
    v_cvt_pk_bf16_f32 v76, v40, v41
    v_cvt_pk_bf16_f32 v77, v42, v43
    v_cvt_pk_bf16_f32 v78, v44, v45
    v_cvt_pk_bf16_f32 v79, v46, v47
    s_nop 1
    v_permlane32_swap_b32 v72, v74
    v_permlane32_swap_b32 v73, v75
    v_permlane32_swap_b32 v76, v78
    v_permlane32_swap_b32 v77, v79
    ds_write_b128 v114, v[72:75] offset:14848
    ds_write_b128 v114, v[76:79] offset:14880
    v_cvt_pk_bf16_f32 v64, v48, v49
    v_cvt_pk_bf16_f32 v65, v50, v51
    v_cvt_pk_bf16_f32 v66, v52, v53
    v_cvt_pk_bf16_f32 v67, v54, v55
    v_cvt_pk_bf16_f32 v68, v56, v57
    v_cvt_pk_bf16_f32 v69, v58, v59
    v_cvt_pk_bf16_f32 v70, v60, v61
    v_cvt_pk_bf16_f32 v71, v62, v63
    s_nop 1
    v_permlane32_swap_b32 v64, v66
    v_permlane32_swap_b32 v65, v67
    v_permlane32_swap_b32 v68, v70
    v_permlane32_swap_b32 v69, v71
    ds_write_b128 v114, v[64:67] offset:29696
    ds_write_b128 v114, v[68:71] offset:29728
    s_waitcnt lgkmcnt(0)
    s_branch L_ar_fin
L_ar_idle:
    s_barrier
    s_barrier
    s_barrier
    s_barrier
    s_barrier
    s_barrier
    s_barrier
    s_barrier
    s_barrier
    s_barrier
L_ar_fin:
    s_barrier
    s_cmp_ge_u32 s27, 4
    s_cbranch_scc1 L_loc_done
    v_lshrrev_b32 v10, 2, v0
    v_add_u32 v11, s38, v10
    v_mul_u32_u24 v11, 464, v11
    v_and_b32 v1, 3, v0
    v_mul_u32_u24 v1, 36, v1
    v_add_u32 v2, v11, v1
    ds_read2_b32 v[12:13], v2 offset0:0 offset1:1
    ds_read2_b32 v[14:15], v2 offset0:2 offset1:3
    ds_read2_b32 v[16:17], v2 offset0:4 offset1:5
    ds_read2_b32 v[18:19], v2 offset0:6 offset1:7
    ds_read_b32 v20, v2 offset:32
    v_subrev_u32 v3, 928, v2
    v_subrev_u32 v4, 1856, v2
    v_subrev_u32 v5, 2784, v2
    v_subrev_u32 v6, 3712, v2
    v_subrev_u32 v7, 4640, v2
    v_subrev_u32 v8, 5568, v2
    v_subrev_u32 v9, 6496, v2
    s_cmp_lg_u32 s36, 0
    s_cbranch_scc1 L_loc_nm1
    v_cmp_le_u32 vcc, 2, v10
    s_nop 1
    v_cndmask_b32 v3, v2, v3, vcc
    v_cmp_le_u32 vcc, 4, v10
    s_nop 1
    v_cndmask_b32 v4, v2, v4, vcc
    v_cmp_le_u32 vcc, 6, v10
    s_nop 1
    v_cndmask_b32 v5, v2, v5, vcc
    v_cmp_le_u32 vcc, 8, v10
    s_nop 1
    v_cndmask_b32 v6, v2, v6, vcc
    v_cmp_le_u32 vcc, 10, v10
    s_nop 1
    v_cndmask_b32 v7, v2, v7, vcc
    v_cmp_le_u32 vcc, 12, v10
    s_nop 1
    v_cndmask_b32 v8, v2, v8, vcc
    v_cmp_le_u32 vcc, 14, v10
    s_nop 1
    v_cndmask_b32 v9, v2, v9, vcc
L_loc_nm1:
    ds_read2_b32 v[22:23], v2 offset0:36 offset1:37
    ds_read2_b32 v[24:25], v2 offset0:38 offset1:39
    ds_read2_b32 v[26:27], v2 offset0:40 offset1:41
    ds_read2_b32 v[28:29], v2 offset0:42 offset1:43
    ds_read_b32 v30, v2 offset:176
    ds_read2_b32 v[32:33], v3 offset0:36 offset1:37
    ds_read2_b32 v[34:35], v3 offset0:38 offset1:39
    ds_read2_b32 v[36:37], v3 offset0:40 offset1:41
    ds_read2_b32 v[38:39], v3 offset0:42 offset1:43
    ds_read_b32 v40, v3 offset:176
    ds_read2_b32 v[42:43], v4 offset0:36 offset1:37
    ds_read2_b32 v[44:45], v4 offset0:38 offset1:39
    ds_read2_b32 v[46:47], v4 offset0:40 offset1:41
    ds_read2_b32 v[48:49], v4 offset0:42 offset1:43
    ds_read_b32 v50, v4 offset:176
    ds_read2_b32 v[52:53], v5 offset0:36 offset1:37
    ds_read2_b32 v[54:55], v5 offset0:38 offset1:39
    ds_read2_b32 v[56:57], v5 offset0:40 offset1:41
    ds_read2_b32 v[58:59], v5 offset0:42 offset1:43
    ds_read_b32 v60, v5 offset:176
    ds_read2_b32 v[62:63], v6 offset0:36 offset1:37
    ds_read2_b32 v[64:65], v6 offset0:38 offset1:39
    ds_read2_b32 v[66:67], v6 offset0:40 offset1:41
    ds_read2_b32 v[68:69], v6 offset0:42 offset1:43
    ds_read_b32 v70, v6 offset:176
    ds_read2_b32 v[72:73], v7 offset0:36 offset1:37
    ds_read2_b32 v[74:75], v7 offset0:38 offset1:39
    ds_read2_b32 v[76:77], v7 offset0:40 offset1:41
    ds_read2_b32 v[78:79], v7 offset0:42 offset1:43
    ds_read_b32 v80, v7 offset:176
    ds_read2_b32 v[82:83], v8 offset0:36 offset1:37
    ds_read2_b32 v[84:85], v8 offset0:38 offset1:39
    ds_read2_b32 v[86:87], v8 offset0:40 offset1:41
    ds_read2_b32 v[88:89], v8 offset0:42 offset1:43
    ds_read_b32 v90, v8 offset:176
    ds_read2_b32 v[92:93], v9 offset0:36 offset1:37
    ds_read2_b32 v[94:95], v9 offset0:38 offset1:39
    ds_read2_b32 v[96:97], v9 offset0:40 offset1:41
    ds_read2_b32 v[98:99], v9 offset0:42 offset1:43
    ds_read_b32 v100, v9 offset:176
    s_mov_b32 s24, 0x3eae1a93
    s_waitcnt lgkmcnt(0)
    v_dot2_f32_bf16 v102, v12, v22, 0
    v_dot2_f32_bf16 v102, v13, v23, v102
    v_dot2_f32_bf16 v102, v14, v24, v102
    v_dot2_f32_bf16 v102, v15, v25, v102
    v_dot2_f32_bf16 v102, v16, v26, v102
    v_dot2_f32_bf16 v102, v17, v27, v102
    v_dot2_f32_bf16 v102, v18, v28, v102
    v_dot2_f32_bf16 v102, v19, v29, v102
    v_dot2_f32_bf16 v102, v20, v30, v102
    ds_read2_b32 v[22:23], v2 offset0:72 offset1:73
    ds_read2_b32 v[24:25], v2 offset0:74 offset1:75
    ds_read2_b32 v[26:27], v2 offset0:76 offset1:77
    ds_read2_b32 v[28:29], v2 offset0:78 offset1:79
    ds_read_b32 v30, v2 offset:320
    v_dot2_f32_bf16 v103, v12, v32, 0
    v_dot2_f32_bf16 v103, v13, v33, v103
    v_dot2_f32_bf16 v103, v14, v34, v103
    v_dot2_f32_bf16 v103, v15, v35, v103
    v_dot2_f32_bf16 v103, v16, v36, v103
    v_dot2_f32_bf16 v103, v17, v37, v103
    v_dot2_f32_bf16 v103, v18, v38, v103
    v_dot2_f32_bf16 v103, v19, v39, v103
    v_dot2_f32_bf16 v103, v20, v40, v103
    ds_read2_b32 v[32:33], v3 offset0:72 offset1:73
    ds_read2_b32 v[34:35], v3 offset0:74 offset1:75
    ds_read2_b32 v[36:37], v3 offset0:76 offset1:77
    ds_read2_b32 v[38:39], v3 offset0:78 offset1:79
    ds_read_b32 v40, v3 offset:320
    v_dot2_f32_bf16 v104, v12, v42, 0
    v_dot2_f32_bf16 v104, v13, v43, v104
    v_dot2_f32_bf16 v104, v14, v44, v104
    v_dot2_f32_bf16 v104, v15, v45, v104
    v_dot2_f32_bf16 v104, v16, v46, v104
    v_dot2_f32_bf16 v104, v17, v47, v104
    v_dot2_f32_bf16 v104, v18, v48, v104
    v_dot2_f32_bf16 v104, v19, v49, v104
    v_dot2_f32_bf16 v104, v20, v50, v104
    ds_read2_b32 v[42:43], v4 offset0:72 offset1:73
    ds_read2_b32 v[44:45], v4 offset0:74 offset1:75
    ds_read2_b32 v[46:47], v4 offset0:76 offset1:77
    ds_read2_b32 v[48:49], v4 offset0:78 offset1:79
    ds_read_b32 v50, v4 offset:320
    v_dot2_f32_bf16 v105, v12, v52, 0
    v_dot2_f32_bf16 v105, v13, v53, v105
    v_dot2_f32_bf16 v105, v14, v54, v105
    v_dot2_f32_bf16 v105, v15, v55, v105
    v_dot2_f32_bf16 v105, v16, v56, v105
    v_dot2_f32_bf16 v105, v17, v57, v105
    v_dot2_f32_bf16 v105, v18, v58, v105
    v_dot2_f32_bf16 v105, v19, v59, v105
    v_dot2_f32_bf16 v105, v20, v60, v105
    ds_read2_b32 v[52:53], v5 offset0:72 offset1:73
    ds_read2_b32 v[54:55], v5 offset0:74 offset1:75
    ds_read2_b32 v[56:57], v5 offset0:76 offset1:77
    ds_read2_b32 v[58:59], v5 offset0:78 offset1:79
    ds_read_b32 v60, v5 offset:320
    v_dot2_f32_bf16 v106, v12, v62, 0
    v_dot2_f32_bf16 v106, v13, v63, v106
    v_dot2_f32_bf16 v106, v14, v64, v106
    v_dot2_f32_bf16 v106, v15, v65, v106
    v_dot2_f32_bf16 v106, v16, v66, v106
    v_dot2_f32_bf16 v106, v17, v67, v106
    v_dot2_f32_bf16 v106, v18, v68, v106
    v_dot2_f32_bf16 v106, v19, v69, v106
    v_dot2_f32_bf16 v106, v20, v70, v106
    ds_read2_b32 v[62:63], v6 offset0:72 offset1:73
    ds_read2_b32 v[64:65], v6 offset0:74 offset1:75
    ds_read2_b32 v[66:67], v6 offset0:76 offset1:77
    ds_read2_b32 v[68:69], v6 offset0:78 offset1:79
    ds_read_b32 v70, v6 offset:320
    v_dot2_f32_bf16 v107, v12, v72, 0
    v_dot2_f32_bf16 v107, v13, v73, v107
    v_dot2_f32_bf16 v107, v14, v74, v107
    v_dot2_f32_bf16 v107, v15, v75, v107
    v_dot2_f32_bf16 v107, v16, v76, v107
    v_dot2_f32_bf16 v107, v17, v77, v107
    v_dot2_f32_bf16 v107, v18, v78, v107
    v_dot2_f32_bf16 v107, v19, v79, v107
    v_dot2_f32_bf16 v107, v20, v80, v107
    ds_read2_b32 v[72:73], v7 offset0:72 offset1:73
    ds_read2_b32 v[74:75], v7 offset0:74 offset1:75
    ds_read2_b32 v[76:77], v7 offset0:76 offset1:77
    ds_read2_b32 v[78:79], v7 offset0:78 offset1:79
    ds_read_b32 v80, v7 offset:320
    v_dot2_f32_bf16 v108, v12, v82, 0
    v_dot2_f32_bf16 v108, v13, v83, v108
    v_dot2_f32_bf16 v108, v14, v84, v108
    v_dot2_f32_bf16 v108, v15, v85, v108
    v_dot2_f32_bf16 v108, v16, v86, v108
    v_dot2_f32_bf16 v108, v17, v87, v108
    v_dot2_f32_bf16 v108, v18, v88, v108
    v_dot2_f32_bf16 v108, v19, v89, v108
    v_dot2_f32_bf16 v108, v20, v90, v108
    ds_read2_b32 v[82:83], v8 offset0:72 offset1:73
    ds_read2_b32 v[84:85], v8 offset0:74 offset1:75
    ds_read2_b32 v[86:87], v8 offset0:76 offset1:77
    ds_read2_b32 v[88:89], v8 offset0:78 offset1:79
    ds_read_b32 v90, v8 offset:320
    v_dot2_f32_bf16 v109, v12, v92, 0
    v_dot2_f32_bf16 v109, v13, v93, v109
    v_dot2_f32_bf16 v109, v14, v94, v109
    v_dot2_f32_bf16 v109, v15, v95, v109
    v_dot2_f32_bf16 v109, v16, v96, v109
    v_dot2_f32_bf16 v109, v17, v97, v109
    v_dot2_f32_bf16 v109, v18, v98, v109
    v_dot2_f32_bf16 v109, v19, v99, v109
    v_dot2_f32_bf16 v109, v20, v100, v109
    ds_read2_b32 v[92:93], v9 offset0:72 offset1:73
    ds_read2_b32 v[94:95], v9 offset0:74 offset1:75
    ds_read2_b32 v[96:97], v9 offset0:76 offset1:77
    ds_read2_b32 v[98:99], v9 offset0:78 offset1:79
    ds_read_b32 v100, v9 offset:320
    v_mul_f32 v102, s24, v102
    v_mul_f32 v103, s24, v103
    v_mul_f32 v104, s24, v104
    v_mul_f32 v105, s24, v105
    v_mul_f32 v106, s24, v106
    v_mul_f32 v107, s24, v107
    v_mul_f32 v108, s24, v108
    v_mul_f32 v109, s24, v109
    s_cmp_lg_u32 s36, 0
    s_cbranch_scc1 L_loc_nm2
    v_mov_b32 v13, 0xff800000
    v_cmp_le_u32 vcc, 2, v10
    s_nop 1
    v_cndmask_b32 v103, v13, v103, vcc
    v_cmp_le_u32 vcc, 4, v10
    s_nop 1
    v_cndmask_b32 v104, v13, v104, vcc
    v_cmp_le_u32 vcc, 6, v10
    s_nop 1
    v_cndmask_b32 v105, v13, v105, vcc
    v_cmp_le_u32 vcc, 8, v10
    s_nop 1
    v_cndmask_b32 v106, v13, v106, vcc
    v_cmp_le_u32 vcc, 10, v10
    s_nop 1
    v_cndmask_b32 v107, v13, v107, vcc
    v_cmp_le_u32 vcc, 12, v10
    s_nop 1
    v_cndmask_b32 v108, v13, v108, vcc
    v_cmp_le_u32 vcc, 14, v10
    s_nop 1
    v_cndmask_b32 v109, v13, v109, vcc
L_loc_nm2:
    v_max3_f32 v12, v102, v103, v104
    v_max3_f32 v12, v12, v105, v106
    v_max3_f32 v12, v12, v107, v108
    v_max_f32 v12, v12, v109
    v_sub_f32 v102, v102, v12
    v_sub_f32 v103, v103, v12
    v_sub_f32 v104, v104, v12
    v_sub_f32 v105, v105, v12
    v_sub_f32 v106, v106, v12
    v_sub_f32 v107, v107, v12
    v_sub_f32 v108, v108, v12
    v_sub_f32 v109, v109, v12
    v_exp_f32 v102, v102
    v_exp_f32 v103, v103
    v_exp_f32 v104, v104
    v_exp_f32 v105, v105
    v_exp_f32 v106, v106
    v_exp_f32 v107, v107
    v_exp_f32 v108, v108
    v_exp_f32 v109, v109
    s_nop 0
    v_add_f32 v12, v102, v103
    v_add_f32 v14, v104, v105
    v_add_f32 v15, v106, v107
    v_add_f32 v13, v108, v109
    v_add_f32 v12, v12, v14
    v_add_f32 v13, v13, v15
    v_add_f32 v12, v12, v13
    v_rcp_f32 v12, v12
    s_mov_b32 s24, 0x05040100
    s_mov_b32 s25, 0x07060302
    v_mul_f32 v102, v102, v12
    v_mul_f32 v103, v103, v12
    v_mul_f32 v104, v104, v12
    v_mul_f32 v105, v105, v12
    v_mul_f32 v106, v106, v12
    v_mul_f32 v107, v107, v12
    v_mul_f32 v108, v108, v12
    v_mul_f32 v109, v109, v12
    v_cvt_pk_bf16_f32 v102, v102, v103
    v_cvt_pk_bf16_f32 v103, v104, v105
    v_cvt_pk_bf16_f32 v104, v106, v107
    v_cvt_pk_bf16_f32 v105, v108, v109
    s_waitcnt lgkmcnt(0)
    v_perm_b32 v12, v32, v22, s24
    v_perm_b32 v13, v32, v22, s25
    v_dot2_f32_bf16 v110, v102, v12, 0
    v_dot2_f32_bf16 v111, v102, v13, 0
    v_perm_b32 v14, v52, v42, s24
    v_perm_b32 v15, v52, v42, s25
    v_dot2_f32_bf16 v110, v103, v14, v110
    v_dot2_f32_bf16 v111, v103, v15, v111
    v_perm_b32 v12, v72, v62, s24
    v_perm_b32 v13, v72, v62, s25
    v_dot2_f32_bf16 v110, v104, v12, v110
    v_dot2_f32_bf16 v111, v104, v13, v111
    v_perm_b32 v14, v92, v82, s24
    v_perm_b32 v15, v92, v82, s25
    v_dot2_f32_bf16 v110, v105, v14, v110
    v_dot2_f32_bf16 v111, v105, v15, v111
    v_perm_b32 v12, v33, v23, s24
    v_perm_b32 v13, v33, v23, s25
    v_dot2_f32_bf16 v112, v102, v12, 0
    v_dot2_f32_bf16 v113, v102, v13, 0
    v_perm_b32 v14, v53, v43, s24
    v_perm_b32 v15, v53, v43, s25
    v_dot2_f32_bf16 v112, v103, v14, v112
    v_dot2_f32_bf16 v113, v103, v15, v113
    v_perm_b32 v12, v73, v63, s24
    v_perm_b32 v13, v73, v63, s25
    v_dot2_f32_bf16 v112, v104, v12, v112
    v_dot2_f32_bf16 v113, v104, v13, v113
    v_perm_b32 v14, v93, v83, s24
    v_perm_b32 v15, v93, v83, s25
    v_dot2_f32_bf16 v112, v105, v14, v112
    v_dot2_f32_bf16 v113, v105, v15, v113
    v_perm_b32 v12, v34, v24, s24
    v_perm_b32 v13, v34, v24, s25
    v_dot2_f32_bf16 v114, v102, v12, 0
    v_dot2_f32_bf16 v115, v102, v13, 0
    v_perm_b32 v14, v54, v44, s24
    v_perm_b32 v15, v54, v44, s25
    v_dot2_f32_bf16 v114, v103, v14, v114
    v_dot2_f32_bf16 v115, v103, v15, v115
    v_perm_b32 v12, v74, v64, s24
    v_perm_b32 v13, v74, v64, s25
    v_dot2_f32_bf16 v114, v104, v12, v114
    v_dot2_f32_bf16 v115, v104, v13, v115
    v_perm_b32 v14, v94, v84, s24
    v_perm_b32 v15, v94, v84, s25
    v_dot2_f32_bf16 v114, v105, v14, v114
    v_dot2_f32_bf16 v115, v105, v15, v115
    v_perm_b32 v12, v35, v25, s24
    v_perm_b32 v13, v35, v25, s25
    v_dot2_f32_bf16 v116, v102, v12, 0
    v_dot2_f32_bf16 v117, v102, v13, 0
    v_perm_b32 v14, v55, v45, s24
    v_perm_b32 v15, v55, v45, s25
    v_dot2_f32_bf16 v116, v103, v14, v116
    v_dot2_f32_bf16 v117, v103, v15, v117
    v_perm_b32 v12, v75, v65, s24
    v_perm_b32 v13, v75, v65, s25
    v_dot2_f32_bf16 v116, v104, v12, v116
    v_dot2_f32_bf16 v117, v104, v13, v117
    v_perm_b32 v14, v95, v85, s24
    v_perm_b32 v15, v95, v85, s25
    v_dot2_f32_bf16 v116, v105, v14, v116
    v_dot2_f32_bf16 v117, v105, v15, v117
    v_perm_b32 v12, v36, v26, s24
    v_perm_b32 v13, v36, v26, s25
    v_dot2_f32_bf16 v118, v102, v12, 0
    v_dot2_f32_bf16 v119, v102, v13, 0
    v_perm_b32 v14, v56, v46, s24
    v_perm_b32 v15, v56, v46, s25
    v_dot2_f32_bf16 v118, v103, v14, v118
    v_dot2_f32_bf16 v119, v103, v15, v119
    v_perm_b32 v12, v76, v66, s24
    v_perm_b32 v13, v76, v66, s25
    v_dot2_f32_bf16 v118, v104, v12, v118
    v_dot2_f32_bf16 v119, v104, v13, v119
    v_perm_b32 v14, v96, v86, s24
    v_perm_b32 v15, v96, v86, s25
    v_dot2_f32_bf16 v118, v105, v14, v118
    v_dot2_f32_bf16 v119, v105, v15, v119
    v_perm_b32 v12, v37, v27, s24
    v_perm_b32 v13, v37, v27, s25
    v_dot2_f32_bf16 v120, v102, v12, 0
    v_dot2_f32_bf16 v121, v102, v13, 0
    v_perm_b32 v14, v57, v47, s24
    v_perm_b32 v15, v57, v47, s25
    v_dot2_f32_bf16 v120, v103, v14, v120
    v_dot2_f32_bf16 v121, v103, v15, v121
    v_perm_b32 v12, v77, v67, s24
    v_perm_b32 v13, v77, v67, s25
    v_dot2_f32_bf16 v120, v104, v12, v120
    v_dot2_f32_bf16 v121, v104, v13, v121
    v_perm_b32 v14, v97, v87, s24
    v_perm_b32 v15, v97, v87, s25
    v_dot2_f32_bf16 v120, v105, v14, v120
    v_dot2_f32_bf16 v121, v105, v15, v121
    v_perm_b32 v12, v38, v28, s24
    v_perm_b32 v13, v38, v28, s25
    v_dot2_f32_bf16 v122, v102, v12, 0
    v_dot2_f32_bf16 v123, v102, v13, 0
    v_perm_b32 v14, v58, v48, s24
    v_perm_b32 v15, v58, v48, s25
    v_dot2_f32_bf16 v122, v103, v14, v122
    v_dot2_f32_bf16 v123, v103, v15, v123
    v_perm_b32 v12, v78, v68, s24
    v_perm_b32 v13, v78, v68, s25
    v_dot2_f32_bf16 v122, v104, v12, v122
    v_dot2_f32_bf16 v123, v104, v13, v123
    v_perm_b32 v14, v98, v88, s24
    v_perm_b32 v15, v98, v88, s25
    v_dot2_f32_bf16 v122, v105, v14, v122
    v_dot2_f32_bf16 v123, v105, v15, v123
    v_perm_b32 v12, v39, v29, s24
    v_perm_b32 v13, v39, v29, s25
    v_dot2_f32_bf16 v124, v102, v12, 0
    v_dot2_f32_bf16 v125, v102, v13, 0
    v_perm_b32 v14, v59, v49, s24
    v_perm_b32 v15, v59, v49, s25
    v_dot2_f32_bf16 v124, v103, v14, v124
    v_dot2_f32_bf16 v125, v103, v15, v125
    v_perm_b32 v12, v79, v69, s24
    v_perm_b32 v13, v79, v69, s25
    v_dot2_f32_bf16 v124, v104, v12, v124
    v_dot2_f32_bf16 v125, v104, v13, v125
    v_perm_b32 v14, v99, v89, s24
    v_perm_b32 v15, v99, v89, s25
    v_dot2_f32_bf16 v124, v105, v14, v124
    v_dot2_f32_bf16 v125, v105, v15, v125
    v_perm_b32 v12, v40, v30, s24
    v_perm_b32 v13, v40, v30, s25
    v_dot2_f32_bf16 v126, v102, v12, 0
    v_dot2_f32_bf16 v127, v102, v13, 0
    v_perm_b32 v14, v60, v50, s24
    v_perm_b32 v15, v60, v50, s25
    v_dot2_f32_bf16 v126, v103, v14, v126
    v_dot2_f32_bf16 v127, v103, v15, v127
    v_perm_b32 v12, v80, v70, s24
    v_perm_b32 v13, v80, v70, s25
    v_dot2_f32_bf16 v126, v104, v12, v126
    v_dot2_f32_bf16 v127, v104, v13, v127
    v_perm_b32 v14, v100, v90, s24
    v_perm_b32 v15, v100, v90, s25
    v_dot2_f32_bf16 v126, v105, v14, v126
    v_dot2_f32_bf16 v127, v105, v15, v127
    s_mul_i32 s39, s36, 64
    v_add_u32 v17, s39, v10
    v_mul_u32_u24 v16, 1152, v17
    v_add_u32 v16, v16, v1
    v_cvt_pk_bf16_f32 v24, v110, v111
    v_cvt_pk_bf16_f32 v25, v112, v113
    v_cvt_pk_bf16_f32 v26, v114, v115
    v_cvt_pk_bf16_f32 v27, v116, v117
    v_cvt_pk_bf16_f32 v28, v118, v119
    v_cvt_pk_bf16_f32 v29, v120, v121
    v_cvt_pk_bf16_f32 v30, v122, v123
    v_cvt_pk_bf16_f32 v31, v124, v125
    v_cvt_pk_bf16_f32 v32, v126, v127
    s_mul_i32 s24, s37, 144
    s_add_u32 s24, s24, 4980736
    buffer_store_dwordx4 v[24:27], v16, s[16:19], s24 offen
    buffer_store_dwordx4 v[28:31], v16, s[16:19], s24 offen offset:16
    buffer_store_dword v32, v16, s[16:19], s24 offen offset:32
L_loc_done:
    s_endpgm
L_k2_end:
    s_endpgm

.globl outp_kernel
.p2align 8
.type outp_kernel,@function
outp_kernel:
    s_cmp_ge_u32 s2, 192
    s_cbranch_scc1 L_outp_end
    s_load_dwordx2 s[44:45], s[0:1], 16
    s_load_dwordx4 s[52:55], s[0:1], 56
    s_load_dwordx2 s[56:57], s[0:1], 80
    v_lshrrev_b32 v1, 6, v0
    s_and_b32 s3, s2, 7
    v_readfirstlane_b32 s27, v1
    s_lshr_b32 s4, s2, 3
    s_and_b32 s5, s4, 1
    s_bfe_u32 s37, s4, 0x10001
    s_lshr_b32 s6, s4, 2
    s_lshl_b32 s36, s3, 1
    s_add_u32 s36, s36, s5
    s_cmp_eq_u32 s37, 0
    s_mov_b32 s35, 2621440
    s_cselect_b32 s35, 4980736, s35
    s_mul_i32 s20, s36, 147456
    s_add_u32 s20, s20, s35
    s_mul_i32 s21, s6, 192
    s_mov_b32 s22, 1152
    s_mul_i32 s23, s36, 294912
    s_add_u32 s23, s23, s21
    s_mul_i32 s35, s37, 1152
    s_add_u32 s23, s23, s35
    s_mov_b32 s24, 2304
    s_mov_b32 s25, 3
    s_cmp_ge_u32 s27, 4
    s_cbranch_scc1 L_op_w4
    v_and_b32 v1, 63, v0
    s_lshl_b32 s29, s27, 3
    v_lshrrev_b32 v6, 3, v1
    v_add_u32 v6, s29, v6
    v_mul_u32_u24 v6, 1152, v6
    v_lshrrev_b32 v7, 4, v1
    s_lshl_b32 s29, s27, 2
    v_add_u32 v7, s29, v7
    v_and_b32 v7, 7, v7
    v_and_b32 v8, 7, v1
    v_xor_b32 v7, v7, v8
    v_lshl_add_u32 v67, v7, 4, v6
    v_add_u32 v68, 36864, v67
    v_add_u32 v69, 73728, v67
    v_add_u32 v70, 110592, v67
    s_lshl_b32 s33, s27, 10
    s_add_u32 s33, s33, 61440
    s_mov_b32 s28, 22369622
    v_lshlrev_b32 v6, 4, v1
    v_mul_hi_u32 v7, v6, s28
    v_mul_u32_u24 v8, 192, v7
    v_sub_u32 v8, v6, v8
    v_mul_lo_u32 v7, v7, s22
    v_add_u32 v64, v7, v8
    v_lshlrev_b32 v6, 4, v1
    v_add_u32 v6, 1024, v6
    v_mul_hi_u32 v7, v6, s28
    v_mul_u32_u24 v8, 192, v7
    v_sub_u32 v8, v6, v8
    v_mul_lo_u32 v7, v7, s22
    v_add_u32 v65, v7, v8
    v_lshlrev_b32 v6, 4, v1
    v_add_u32 v6, 2048, v6
    v_mul_hi_u32 v7, v6, s28
    v_mul_u32_u24 v8, 192, v7
    v_sub_u32 v8, v6, v8
    v_mul_lo_u32 v7, v7, s22
    v_add_u32 v66, v7, v8
    s_lshl_b32 s31, s22, 4
    s_mul_i32 s30, s31, s27
    s_add_u32 s30, s30, s21
    s_lshl_b32 s31, s22, 6
    s_mul_i32 s32, s27, 3072
    s_cmp_eq_u32 s37, 0
    s_waitcnt lgkmcnt(0)
    s_cselect_b32 s12, s44, s52
    s_cselect_b32 s13, s45, s53
    s_mov_b32 s14, 663552
    s_mov_b32 s15, 0x00020000
    s_mov_b32 s8, s56
    s_mov_b32 s9, s57
    s_mov_b32 s10, 16777216
    s_mov_b32 s11, 0x00020000
    s_mov_b32 s16, s54
    s_mov_b32 s17, s55
    s_mov_b32 s18, 4718592
    s_mov_b32 s19, 0x00020000
    s_add_u32 m0, s32, 0
    s_nop 0
    buffer_load_dwordx4 v64, s[12:15], s30 offen lds
    s_add_u32 m0, s32, 1024
    s_nop 0
    buffer_load_dwordx4 v65, s[12:15], s30 offen lds
    s_add_u32 m0, s32, 2048
    s_nop 0
    buffer_load_dwordx4 v66, s[12:15], s30 offen lds
    s_add_u32 s30, s30, s31
    s_add_u32 m0, s33, 0
    s_nop 0
    buffer_load_dwordx4 v67, s[8:11], s20 offen lds
    s_add_u32 m0, s33, 4096
    s_nop 0
    buffer_load_dwordx4 v68, s[8:11], s20 offen lds
    s_add_u32 m0, s33, 8192
    s_nop 0
    buffer_load_dwordx4 v69, s[8:11], s20 offen lds
    s_add_u32 m0, s33, 12288
    s_nop 0
    buffer_load_dwordx4 v70, s[8:11], s20 offen lds
    s_add_u32 s20, s20, 128
    s_add_u32 m0, s32, 12288
    s_nop 0
    buffer_load_dwordx4 v64, s[12:15], s30 offen lds
    s_add_u32 m0, s32, 13312
    s_nop 0
    buffer_load_dwordx4 v65, s[12:15], s30 offen lds
    s_add_u32 m0, s32, 14336
    s_nop 0
    buffer_load_dwordx4 v66, s[12:15], s30 offen lds
    s_add_u32 s30, s30, s31
    s_add_u32 m0, s33, 16384
    s_nop 0
    buffer_load_dwordx4 v67, s[8:11], s20 offen lds
    s_add_u32 m0, s33, 20480
    s_nop 0
    buffer_load_dwordx4 v68, s[8:11], s20 offen lds
    s_add_u32 m0, s33, 24576
    s_nop 0
    buffer_load_dwordx4 v69, s[8:11], s20 offen lds
    s_add_u32 m0, s33, 28672
    s_nop 0
    buffer_load_dwordx4 v70, s[8:11], s20 offen lds
    s_add_u32 s20, s20, 128
    s_add_u32 m0, s32, 24576
    s_nop 0
    buffer_load_dwordx4 v64, s[12:15], s30 offen lds
    s_add_u32 m0, s32, 25600
    s_nop 0
    buffer_load_dwordx4 v65, s[12:15], s30 offen lds
    s_add_u32 m0, s32, 26624
    s_nop 0
    buffer_load_dwordx4 v66, s[12:15], s30 offen lds
    s_add_u32 s30, s30, s31
    s_add_u32 m0, s33, 32768
    s_nop 0
    buffer_load_dwordx4 v67, s[8:11], s20 offen lds
    s_add_u32 m0, s33, 36864
    s_nop 0
    buffer_load_dwordx4 v68, s[8:11], s20 offen lds
    s_add_u32 m0, s33, 40960
    s_nop 0
    buffer_load_dwordx4 v69, s[8:11], s20 offen lds
    s_add_u32 m0, s33, 45056
    s_nop 0
    buffer_load_dwordx4 v70, s[8:11], s20 offen lds
    s_add_u32 s20, s20, 128
    v_and_b32 v1, 63, v0
    s_and_b32 s34, s27, 3
    s_lshr_b32 s35, s27, 2
    v_lshrrev_b32 v6, 5, v1
    v_lshlrev_b32 v6, 3, v6
    v_bfe_u32 v7, v1, 2, 2
    v_add_u32 v6, v6, v7
    v_mul_u32_u24 v6, 192, v6
    v_bfe_u32 v7, v1, 4, 1
    v_lshlrev_b32 v7, 5, v7
    v_and_b32 v8, 3, v1
    v_lshlrev_b32 v8, 3, v8
    v_add3_u32 v2, v6, v7, v8
    s_mul_i32 s28, s35, 64
    v_add_u32 v2, s28, v2
    v_add_u32 v3, 61440, v2
    v_add_u32 v4, 122880, v2
    v_add_u32 v5, 184320, v2
    v_and_b32 v6, 31, v1
    v_lshrrev_b32 v7, 5, v1
    v_bfe_u32 v8, v1, 1, 3
    v_lshlrev_b32 v10, 7, v6
    s_mul_i32 s28, s34, 4096
    s_add_u32 s28, s28, 61440
    v_add_u32 v10, s28, v10
    v_add_u32 v9, 0, v7
    v_xor_b32 v9, v9, v8
    v_lshl_add_u32 v71, v9, 4, v10
    v_add_u32 v75, 65536, v71
    v_add_u32 v9, 2, v7
    v_xor_b32 v9, v9, v8
    v_lshl_add_u32 v72, v9, 4, v10
    v_add_u32 v76, 65536, v72
    v_add_u32 v9, 4, v7
    v_xor_b32 v9, v9, v8
    v_lshl_add_u32 v73, v9, 4, v10
    v_add_u32 v77, 65536, v73
    v_add_u32 v9, 6, v7
    v_xor_b32 v9, v9, v8
    v_lshl_add_u32 v74, v9, 4, v10
    v_add_u32 v78, 65536, v74
    s_mul_i32 s28, s34, 6656
    s_mul_i32 s29, s35, 64
    s_add_u32 s28, s28, s29
    v_mul_u32_u24 v6, 208, v6
    v_lshl_add_u32 v6, v7, 4, v6
    v_add_u32 v79, s28, v6
    s_waitcnt vmcnt(14)
    s_barrier
    ds_read_b64_tr_b16 v[32:33], v2 offset:0
    ds_read_b64_tr_b16 v[34:35], v2 offset:768
    ds_read_b128 v[48:51], v71 offset:0
    ds_read_b64_tr_b16 v[36:37], v2 offset:3072
    ds_read_b64_tr_b16 v[38:39], v2 offset:3840
    ds_read_b128 v[52:55], v72 offset:0
    ds_read_b64_tr_b16 v[40:41], v2 offset:6144
    ds_read_b64_tr_b16 v[42:43], v2 offset:6912
    ds_read_b128 v[56:59], v73 offset:0
    s_waitcnt lgkmcnt(6)
    v_mfma_f32_32x32x16_bf16 v[16:31], v[32:35], v[48:51], 0
    ds_read_b64_tr_b16 v[44:45], v2 offset:9216
    ds_read_b64_tr_b16 v[46:47], v2 offset:9984
    ds_read_b128 v[60:63], v74 offset:0
    s_add_u32 m0, s32, 36864
    s_nop 0
    buffer_load_dwordx4 v64, s[12:15], s30 offen lds
    s_add_u32 m0, s32, 37888
    s_nop 0
    buffer_load_dwordx4 v65, s[12:15], s30 offen lds
    s_add_u32 m0, s32, 38912
    s_nop 0
    buffer_load_dwordx4 v66, s[12:15], s30 offen lds
    s_add_u32 s30, s30, s31
    s_add_u32 m0, s33, 49152
    s_nop 0
    buffer_load_dwordx4 v67, s[8:11], s20 offen lds
    s_add_u32 m0, s33, 53248
    s_nop 0
    buffer_load_dwordx4 v68, s[8:11], s20 offen lds
    s_add_u32 m0, s33, 57344
    s_nop 0
    buffer_load_dwordx4 v69, s[8:11], s20 offen lds
    s_add_u32 m0, s33, 61440
    s_nop 0
    buffer_load_dwordx4 v70, s[8:11], s20 offen lds
    s_add_u32 s20, s20, 128
    s_add_u32 m0, s32, 49152
    s_nop 0
    buffer_load_dwordx4 v64, s[12:15], s30 offen lds
    s_add_u32 m0, s32, 50176
    s_nop 0
    buffer_load_dwordx4 v65, s[12:15], s30 offen lds
    s_add_u32 m0, s32, 51200
    s_nop 0
    buffer_load_dwordx4 v66, s[12:15], s30 offen lds
    s_add_u32 s30, s30, s31
    s_add_u32 m0, s33, 65536
    s_nop 0
    buffer_load_dwordx4 v67, s[8:11], s20 offen lds
    s_add_u32 m0, s33, 69632
    s_nop 0
    buffer_load_dwordx4 v68, s[8:11], s20 offen lds
    s_add_u32 m0, s33, 73728
    s_nop 0
    buffer_load_dwordx4 v69, s[8:11], s20 offen lds
    s_add_u32 m0, s33, 77824
    s_nop 0
    buffer_load_dwordx4 v70, s[8:11], s20 offen lds
    s_add_u32 s20, s20, 128
    s_waitcnt vmcnt(21)
    s_barrier
    s_waitcnt lgkmcnt(6)
    v_mfma_f32_32x32x16_bf16 v[16:31], v[36:39], v[52:55], v[16:31]
    ds_read_b64_tr_b16 v[32:33], v2 offset:12288
    ds_read_b64_tr_b16 v[34:35], v2 offset:13056
    ds_read_b128 v[48:51], v71 offset:16384
    s_waitcnt lgkmcnt(6)
    v_mfma_f32_32x32x16_bf16 v[16:31], v[40:43], v[56:59], v[16:31]
    ds_read_b64_tr_b16 v[36:37], v2 offset:15360
    ds_read_b64_tr_b16 v[38:39], v2 offset:16128
    ds_read_b128 v[52:55], v72 offset:16384
    s_waitcnt lgkmcnt(6)
    v_mfma_f32_32x32x16_bf16 v[16:31], v[44:47], v[60:63], v[16:31]
    ds_read_b64_tr_b16 v[40:41], v2 offset:18432
    ds_read_b64_tr_b16 v[42:43], v2 offset:19200
    ds_read_b128 v[56:59], v73 offset:16384
    s_waitcnt lgkmcnt(6)
    v_mfma_f32_32x32x16_bf16 v[16:31], v[32:35], v[48:51], v[16:31]
    ds_read_b64_tr_b16 v[44:45], v2 offset:21504
    ds_read_b64_tr_b16 v[46:47], v2 offset:22272
    ds_read_b128 v[60:63], v74 offset:16384
    s_waitcnt vmcnt(14)
    s_barrier
    s_waitcnt lgkmcnt(6)
    v_mfma_f32_32x32x16_bf16 v[16:31], v[36:39], v[52:55], v[16:31]
    ds_read_b64_tr_b16 v[32:33], v2 offset:24576
    ds_read_b64_tr_b16 v[34:35], v2 offset:25344
    ds_read_b128 v[48:51], v71 offset:32768
    s_add_u32 m0, s32, 0
    s_nop 0
    buffer_load_dwordx4 v64, s[12:15], s30 offen lds
    s_add_u32 m0, s32, 1024
    s_nop 0
    buffer_load_dwordx4 v65, s[12:15], s30 offen lds
    s_waitcnt lgkmcnt(6)
    v_mfma_f32_32x32x16_bf16 v[16:31], v[40:43], v[56:59], v[16:31]
    ds_read_b64_tr_b16 v[36:37], v2 offset:27648
    ds_read_b64_tr_b16 v[38:39], v2 offset:28416
    ds_read_b128 v[52:55], v72 offset:32768
    s_add_u32 m0, s32, 2048
    s_nop 0
    buffer_load_dwordx4 v66, s[12:15], s30 offen lds
    s_add_u32 s30, s30, s31
    s_add_u32 m0, s33, 0
    s_nop 0
    buffer_load_dwordx4 v67, s[8:11], s20 offen lds
    s_waitcnt lgkmcnt(6)
    v_mfma_f32_32x32x16_bf16 v[16:31], v[44:47], v[60:63], v[16:31]
    ds_read_b64_tr_b16 v[40:41], v2 offset:30720
    ds_read_b64_tr_b16 v[42:43], v2 offset:31488
    ds_read_b128 v[56:59], v73 offset:32768
    s_add_u32 m0, s33, 4096
    s_nop 0
    buffer_load_dwordx4 v68, s[8:11], s20 offen lds
    s_add_u32 m0, s33, 8192
    s_nop 0
    buffer_load_dwordx4 v69, s[8:11], s20 offen lds
    s_waitcnt lgkmcnt(6)
    v_mfma_f32_32x32x16_bf16 v[16:31], v[32:35], v[48:51], v[16:31]
    ds_read_b64_tr_b16 v[44:45], v2 offset:33792
    ds_read_b64_tr_b16 v[46:47], v2 offset:34560
    ds_read_b128 v[60:63], v74 offset:32768
    s_add_u32 m0, s33, 12288
    s_nop 0
    buffer_load_dwordx4 v70, s[8:11], s20 offen lds
    s_add_u32 s20, s20, 128
    s_waitcnt vmcnt(14)
    s_barrier
    s_waitcnt lgkmcnt(6)
    v_mfma_f32_32x32x16_bf16 v[16:31], v[36:39], v[52:55], v[16:31]
    ds_read_b64_tr_b16 v[32:33], v2 offset:36864
    ds_read_b64_tr_b16 v[34:35], v2 offset:37632
    ds_read_b128 v[48:51], v71 offset:49152
    s_add_u32 m0, s32, 12288
    s_nop 0
    buffer_load_dwordx4 v64, s[12:15], s30 offen lds
    s_add_u32 m0, s32, 13312
    s_nop 0
    buffer_load_dwordx4 v65, s[12:15], s30 offen lds
    s_waitcnt lgkmcnt(6)
    v_mfma_f32_32x32x16_bf16 v[16:31], v[40:43], v[56:59], v[16:31]
    ds_read_b64_tr_b16 v[36:37], v2 offset:39936
    ds_read_b64_tr_b16 v[38:39], v2 offset:40704
    ds_read_b128 v[52:55], v72 offset:49152
    s_add_u32 m0, s32, 14336
    s_nop 0
    buffer_load_dwordx4 v66, s[12:15], s30 offen lds
    s_add_u32 s30, s30, s31
    s_add_u32 m0, s33, 16384
    s_nop 0
    buffer_load_dwordx4 v67, s[8:11], s20 offen lds
    s_waitcnt lgkmcnt(6)
    v_mfma_f32_32x32x16_bf16 v[16:31], v[44:47], v[60:63], v[16:31]
    ds_read_b64_tr_b16 v[40:41], v2 offset:43008
    ds_read_b64_tr_b16 v[42:43], v2 offset:43776
    ds_read_b128 v[56:59], v73 offset:49152
    s_add_u32 m0, s33, 20480
    s_nop 0
    buffer_load_dwordx4 v68, s[8:11], s20 offen lds
    s_add_u32 m0, s33, 24576
    s_nop 0
    buffer_load_dwordx4 v69, s[8:11], s20 offen lds
    s_waitcnt lgkmcnt(6)
    v_mfma_f32_32x32x16_bf16 v[16:31], v[32:35], v[48:51], v[16:31]
    ds_read_b64_tr_b16 v[44:45], v2 offset:46080
    ds_read_b64_tr_b16 v[46:47], v2 offset:46848
    ds_read_b128 v[60:63], v74 offset:49152
    s_add_u32 m0, s33, 28672
    s_nop 0
    buffer_load_dwordx4 v70, s[8:11], s20 offen lds
    s_add_u32 s20, s20, 128
    s_waitcnt vmcnt(14)
    s_barrier
    s_waitcnt lgkmcnt(6)
    v_mfma_f32_32x32x16_bf16 v[16:31], v[36:39], v[52:55], v[16:31]
    ds_read_b64_tr_b16 v[32:33], v2 offset:49152
    ds_read_b64_tr_b16 v[34:35], v2 offset:49920
    ds_read_b128 v[48:51], v75 offset:0
    s_add_u32 m0, s32, 24576
    s_nop 0
    buffer_load_dwordx4 v64, s[12:15], s30 offen lds
    s_add_u32 m0, s32, 25600
    s_nop 0
    buffer_load_dwordx4 v65, s[12:15], s30 offen lds
    s_waitcnt lgkmcnt(6)
    v_mfma_f32_32x32x16_bf16 v[16:31], v[40:43], v[56:59], v[16:31]
    ds_read_b64_tr_b16 v[36:37], v2 offset:52224
    ds_read_b64_tr_b16 v[38:39], v2 offset:52992
    ds_read_b128 v[52:55], v76 offset:0
    s_add_u32 m0, s32, 26624
    s_nop 0
    buffer_load_dwordx4 v66, s[12:15], s30 offen lds
    s_add_u32 s30, s30, s31
    s_add_u32 m0, s33, 32768
    s_nop 0
    buffer_load_dwordx4 v67, s[8:11], s20 offen lds
    s_waitcnt lgkmcnt(6)
    v_mfma_f32_32x32x16_bf16 v[16:31], v[44:47], v[60:63], v[16:31]
    ds_read_b64_tr_b16 v[40:41], v2 offset:55296
    ds_read_b64_tr_b16 v[42:43], v2 offset:56064
    ds_read_b128 v[56:59], v77 offset:0
    s_add_u32 m0, s33, 36864
    s_nop 0
    buffer_load_dwordx4 v68, s[8:11], s20 offen lds
    s_add_u32 m0, s33, 40960
    s_nop 0
    buffer_load_dwordx4 v69, s[8:11], s20 offen lds
    s_waitcnt lgkmcnt(6)
    v_mfma_f32_32x32x16_bf16 v[16:31], v[32:35], v[48:51], v[16:31]
    ds_read_b64_tr_b16 v[44:45], v2 offset:58368
    ds_read_b64_tr_b16 v[46:47], v2 offset:59136
    ds_read_b128 v[60:63], v78 offset:0
    s_add_u32 m0, s33, 45056
    s_nop 0
    buffer_load_dwordx4 v70, s[8:11], s20 offen lds
    s_add_u32 s20, s20, 128
    s_waitcnt vmcnt(14)
    s_barrier
    s_waitcnt lgkmcnt(6)
    v_mfma_f32_32x32x16_bf16 v[16:31], v[36:39], v[52:55], v[16:31]
    ds_read_b64_tr_b16 v[32:33], v2 offset:0
    ds_read_b64_tr_b16 v[34:35], v2 offset:768
    ds_read_b128 v[48:51], v71 offset:0
    s_add_u32 m0, s32, 36864
    s_nop 0
    buffer_load_dwordx4 v64, s[12:15], s30 offen lds
    s_add_u32 m0, s32, 37888
    s_nop 0
    buffer_load_dwordx4 v65, s[12:15], s30 offen lds
    s_waitcnt lgkmcnt(6)
    v_mfma_f32_32x32x16_bf16 v[16:31], v[40:43], v[56:59], v[16:31]
    ds_read_b64_tr_b16 v[36:37], v2 offset:3072
    ds_read_b64_tr_b16 v[38:39], v2 offset:3840
    ds_read_b128 v[52:55], v72 offset:0
    s_add_u32 m0, s32, 38912
    s_nop 0
    buffer_load_dwordx4 v66, s[12:15], s30 offen lds
    s_add_u32 s30, s30, s31
    s_add_u32 m0, s33, 49152
    s_nop 0
    buffer_load_dwordx4 v67, s[8:11], s20 offen lds
    s_waitcnt lgkmcnt(6)
    v_mfma_f32_32x32x16_bf16 v[16:31], v[44:47], v[60:63], v[16:31]
    ds_read_b64_tr_b16 v[40:41], v2 offset:6144
    ds_read_b64_tr_b16 v[42:43], v2 offset:6912
    ds_read_b128 v[56:59], v73 offset:0
    s_add_u32 m0, s33, 53248
    s_nop 0
    buffer_load_dwordx4 v68, s[8:11], s20 offen lds
    s_add_u32 m0, s33, 57344
    s_nop 0
    buffer_load_dwordx4 v69, s[8:11], s20 offen lds
    s_waitcnt lgkmcnt(6)
    v_mfma_f32_32x32x16_bf16 v[16:31], v[32:35], v[48:51], v[16:31]
    ds_read_b64_tr_b16 v[44:45], v2 offset:9216
    ds_read_b64_tr_b16 v[46:47], v2 offset:9984
    ds_read_b128 v[60:63], v74 offset:0
    s_add_u32 m0, s33, 61440
    s_nop 0
    buffer_load_dwordx4 v70, s[8:11], s20 offen lds
    s_add_u32 s20, s20, 128
    s_waitcnt vmcnt(14)
    s_barrier
    s_waitcnt lgkmcnt(6)
    v_mfma_f32_32x32x16_bf16 v[16:31], v[36:39], v[52:55], v[16:31]
    ds_read_b64_tr_b16 v[32:33], v2 offset:12288
    ds_read_b64_tr_b16 v[34:35], v2 offset:13056
    ds_read_b128 v[48:51], v71 offset:16384
    s_waitcnt lgkmcnt(6)
    v_mfma_f32_32x32x16_bf16 v[16:31], v[40:43], v[56:59], v[16:31]
    ds_read_b64_tr_b16 v[36:37], v2 offset:15360
    ds_read_b64_tr_b16 v[38:39], v2 offset:16128
    ds_read_b128 v[52:55], v72 offset:16384
    s_waitcnt lgkmcnt(6)
    v_mfma_f32_32x32x16_bf16 v[16:31], v[44:47], v[60:63], v[16:31]
    ds_read_b64_tr_b16 v[40:41], v2 offset:18432
    ds_read_b64_tr_b16 v[42:43], v2 offset:19200
    ds_read_b128 v[56:59], v73 offset:16384
    s_waitcnt lgkmcnt(6)
    v_mfma_f32_32x32x16_bf16 v[16:31], v[32:35], v[48:51], v[16:31]
    ds_read_b64_tr_b16 v[44:45], v2 offset:21504
    ds_read_b64_tr_b16 v[46:47], v2 offset:22272
    ds_read_b128 v[60:63], v74 offset:16384
    s_waitcnt vmcnt(7)
    s_barrier
    s_waitcnt lgkmcnt(6)
    v_mfma_f32_32x32x16_bf16 v[16:31], v[36:39], v[52:55], v[16:31]
    ds_read_b64_tr_b16 v[32:33], v2 offset:24576
    ds_read_b64_tr_b16 v[34:35], v2 offset:25344
    ds_read_b128 v[48:51], v71 offset:32768
    s_waitcnt lgkmcnt(6)
    v_mfma_f32_32x32x16_bf16 v[16:31], v[40:43], v[56:59], v[16:31]
    ds_read_b64_tr_b16 v[36:37], v2 offset:27648
    ds_read_b64_tr_b16 v[38:39], v2 offset:28416
    ds_read_b128 v[52:55], v72 offset:32768
    s_waitcnt lgkmcnt(6)
    v_mfma_f32_32x32x16_bf16 v[16:31], v[44:47], v[60:63], v[16:31]
    ds_read_b64_tr_b16 v[40:41], v2 offset:30720
    ds_read_b64_tr_b16 v[42:43], v2 offset:31488
    ds_read_b128 v[56:59], v73 offset:32768
    s_waitcnt lgkmcnt(6)
    v_mfma_f32_32x32x16_bf16 v[16:31], v[32:35], v[48:51], v[16:31]
    ds_read_b64_tr_b16 v[44:45], v2 offset:33792
    ds_read_b64_tr_b16 v[46:47], v2 offset:34560
    ds_read_b128 v[60:63], v74 offset:32768
    s_waitcnt vmcnt(0)
    s_barrier
    s_waitcnt lgkmcnt(6)
    v_mfma_f32_32x32x16_bf16 v[16:31], v[36:39], v[52:55], v[16:31]
    ds_read_b64_tr_b16 v[32:33], v2 offset:36864
    ds_read_b64_tr_b16 v[34:35], v2 offset:37632
    ds_read_b128 v[48:51], v71 offset:49152
    s_waitcnt lgkmcnt(6)
    v_mfma_f32_32x32x16_bf16 v[16:31], v[40:43], v[56:59], v[16:31]
    ds_read_b64_tr_b16 v[36:37], v2 offset:39936
    ds_read_b64_tr_b16 v[38:39], v2 offset:40704
    ds_read_b128 v[52:55], v72 offset:49152
    s_waitcnt lgkmcnt(6)
    v_mfma_f32_32x32x16_bf16 v[16:31], v[44:47], v[60:63], v[16:31]
    ds_read_b64_tr_b16 v[40:41], v2 offset:43008
    ds_read_b64_tr_b16 v[42:43], v2 offset:43776
    ds_read_b128 v[56:59], v73 offset:49152
    s_waitcnt lgkmcnt(6)
    v_mfma_f32_32x32x16_bf16 v[16:31], v[32:35], v[48:51], v[16:31]
    ds_read_b64_tr_b16 v[44:45], v2 offset:46080
    ds_read_b64_tr_b16 v[46:47], v2 offset:46848
    ds_read_b128 v[60:63], v74 offset:49152
    s_waitcnt lgkmcnt(6)
    v_mfma_f32_32x32x16_bf16 v[16:31], v[36:39], v[52:55], v[16:31]
    s_waitcnt lgkmcnt(3)
    v_mfma_f32_32x32x16_bf16 v[16:31], v[40:43], v[56:59], v[16:31]
    s_waitcnt lgkmcnt(0)
    v_mfma_f32_32x32x16_bf16 v[16:31], v[44:47], v[60:63], v[16:31]
    s_barrier
    s_mov_b32 s28, 0x3eae1a93
    s_nop 12
    v_cvt_pk_bf16_f32 v32, v16, v17
    v_cvt_pk_bf16_f32 v33, v18, v19
    v_cvt_pk_bf16_f32 v34, v20, v21
    v_cvt_pk_bf16_f32 v35, v22, v23
    v_cvt_pk_bf16_f32 v36, v24, v25
    v_cvt_pk_bf16_f32 v37, v26, v27
    v_cvt_pk_bf16_f32 v38, v28, v29
    v_cvt_pk_bf16_f32 v39, v30, v31
    s_nop 1
    v_permlane32_swap_b32 v32, v34
    v_permlane32_swap_b32 v33, v35
    v_permlane32_swap_b32 v36, v38
    v_permlane32_swap_b32 v37, v39
    ds_write_b128 v79, v[32:35] offset:0
    ds_write_b128 v79, v[36:39] offset:32
    s_waitcnt lgkmcnt(0)
    s_branch L_op_fin
L_op_w4:
    s_cmp_eq_u32 s37, 0
    s_waitcnt lgkmcnt(0)
    s_cselect_b32 s12, s44, s52
    s_cselect_b32 s13, s45, s53
    s_mov_b32 s14, 663552
    s_mov_b32 s15, 0x00020000
    s_mov_b32 s8, s56
    s_mov_b32 s9, s57
    s_mov_b32 s10, 16777216
    s_mov_b32 s11, 0x00020000
    s_mov_b32 s16, s54
    s_mov_b32 s17, s55
    s_mov_b32 s18, 4718592
    s_mov_b32 s19, 0x00020000
    v_and_b32 v1, 63, v0
    s_and_b32 s34, s27, 3
    s_lshr_b32 s35, s27, 2
    v_lshrrev_b32 v6, 5, v1
    v_lshlrev_b32 v6, 3, v6
    v_bfe_u32 v7, v1, 2, 2
    v_add_u32 v6, v6, v7
    v_mul_u32_u24 v6, 192, v6
    v_bfe_u32 v7, v1, 4, 1
    v_lshlrev_b32 v7, 5, v7
    v_and_b32 v8, 3, v1
    v_lshlrev_b32 v8, 3, v8
    v_add3_u32 v2, v6, v7, v8
    s_mul_i32 s28, s35, 64
    v_add_u32 v2, s28, v2
    v_add_u32 v3, 61440, v2
    v_add_u32 v4, 122880, v2
    v_add_u32 v5, 184320, v2
    v_and_b32 v6, 31, v1
    v_lshrrev_b32 v7, 5, v1
    v_bfe_u32 v8, v1, 1, 3
    v_lshlrev_b32 v10, 7, v6
    s_mul_i32 s28, s34, 4096
    s_add_u32 s28, s28, 61440
    v_add_u32 v10, s28, v10
    v_add_u32 v9, 0, v7
    v_xor_b32 v9, v9, v8
    v_lshl_add_u32 v71, v9, 4, v10
    v_add_u32 v75, 65536, v71
    v_add_u32 v9, 2, v7
    v_xor_b32 v9, v9, v8
    v_lshl_add_u32 v72, v9, 4, v10
    v_add_u32 v76, 65536, v72
    v_add_u32 v9, 4, v7
    v_xor_b32 v9, v9, v8
    v_lshl_add_u32 v73, v9, 4, v10
    v_add_u32 v77, 65536, v73
    v_add_u32 v9, 6, v7
    v_xor_b32 v9, v9, v8
    v_lshl_add_u32 v74, v9, 4, v10
    v_add_u32 v78, 65536, v74
    s_mul_i32 s28, s34, 6656
    s_mul_i32 s29, s35, 64
    s_add_u32 s28, s28, s29
    v_mul_u32_u24 v6, 208, v6
    v_lshl_add_u32 v6, v7, 4, v6
    v_add_u32 v79, s28, v6
    s_barrier
    ds_read_b64_tr_b16 v[32:33], v2 offset:0
    ds_read_b64_tr_b16 v[34:35], v2 offset:768
    ds_read_b128 v[48:51], v71 offset:0
    ds_read_b64_tr_b16 v[36:37], v2 offset:3072
    ds_read_b64_tr_b16 v[38:39], v2 offset:3840
    ds_read_b128 v[52:55], v72 offset:0
    ds_read_b64_tr_b16 v[40:41], v2 offset:6144
    ds_read_b64_tr_b16 v[42:43], v2 offset:6912
    ds_read_b128 v[56:59], v73 offset:0
    s_waitcnt lgkmcnt(6)
    v_mfma_f32_32x32x16_bf16 v[16:31], v[32:35], v[48:51], 0
    ds_read_b64_tr_b16 v[44:45], v2 offset:9216
    ds_read_b64_tr_b16 v[46:47], v2 offset:9984
    ds_read_b128 v[60:63], v74 offset:0
    s_barrier
    s_waitcnt lgkmcnt(6)
    v_mfma_f32_32x32x16_bf16 v[16:31], v[36:39], v[52:55], v[16:31]
    ds_read_b64_tr_b16 v[32:33], v2 offset:12288
    ds_read_b64_tr_b16 v[34:35], v2 offset:13056
    ds_read_b128 v[48:51], v71 offset:16384
    s_waitcnt lgkmcnt(6)
    v_mfma_f32_32x32x16_bf16 v[16:31], v[40:43], v[56:59], v[16:31]
    ds_read_b64_tr_b16 v[36:37], v2 offset:15360
    ds_read_b64_tr_b16 v[38:39], v2 offset:16128
    ds_read_b128 v[52:55], v72 offset:16384
    s_waitcnt lgkmcnt(6)
    v_mfma_f32_32x32x16_bf16 v[16:31], v[44:47], v[60:63], v[16:31]
    ds_read_b64_tr_b16 v[40:41], v2 offset:18432
    ds_read_b64_tr_b16 v[42:43], v2 offset:19200
    ds_read_b128 v[56:59], v73 offset:16384
    s_waitcnt lgkmcnt(6)
    v_mfma_f32_32x32x16_bf16 v[16:31], v[32:35], v[48:51], v[16:31]
    ds_read_b64_tr_b16 v[44:45], v2 offset:21504
    ds_read_b64_tr_b16 v[46:47], v2 offset:22272
    ds_read_b128 v[60:63], v74 offset:16384
    s_barrier
    s_waitcnt lgkmcnt(6)
    v_mfma_f32_32x32x16_bf16 v[16:31], v[36:39], v[52:55], v[16:31]
    ds_read_b64_tr_b16 v[32:33], v2 offset:24576
    ds_read_b64_tr_b16 v[34:35], v2 offset:25344
    ds_read_b128 v[48:51], v71 offset:32768
    s_waitcnt lgkmcnt(6)
    v_mfma_f32_32x32x16_bf16 v[16:31], v[40:43], v[56:59], v[16:31]
    ds_read_b64_tr_b16 v[36:37], v2 offset:27648
    ds_read_b64_tr_b16 v[38:39], v2 offset:28416
    ds_read_b128 v[52:55], v72 offset:32768
    s_waitcnt lgkmcnt(6)
    v_mfma_f32_32x32x16_bf16 v[16:31], v[44:47], v[60:63], v[16:31]
    ds_read_b64_tr_b16 v[40:41], v2 offset:30720
    ds_read_b64_tr_b16 v[42:43], v2 offset:31488
    ds_read_b128 v[56:59], v73 offset:32768
    s_waitcnt lgkmcnt(6)
    v_mfma_f32_32x32x16_bf16 v[16:31], v[32:35], v[48:51], v[16:31]
    ds_read_b64_tr_b16 v[44:45], v2 offset:33792
    ds_read_b64_tr_b16 v[46:47], v2 offset:34560
    ds_read_b128 v[60:63], v74 offset:32768
    s_barrier
    s_waitcnt lgkmcnt(6)
    v_mfma_f32_32x32x16_bf16 v[16:31], v[36:39], v[52:55], v[16:31]
    ds_read_b64_tr_b16 v[32:33], v2 offset:36864
    ds_read_b64_tr_b16 v[34:35], v2 offset:37632
    ds_read_b128 v[48:51], v71 offset:49152
    s_waitcnt lgkmcnt(6)
    v_mfma_f32_32x32x16_bf16 v[16:31], v[40:43], v[56:59], v[16:31]
    ds_read_b64_tr_b16 v[36:37], v2 offset:39936
    ds_read_b64_tr_b16 v[38:39], v2 offset:40704
    ds_read_b128 v[52:55], v72 offset:49152
    s_waitcnt lgkmcnt(6)
    v_mfma_f32_32x32x16_bf16 v[16:31], v[44:47], v[60:63], v[16:31]
    ds_read_b64_tr_b16 v[40:41], v2 offset:43008
    ds_read_b64_tr_b16 v[42:43], v2 offset:43776
    ds_read_b128 v[56:59], v73 offset:49152
    s_waitcnt lgkmcnt(6)
    v_mfma_f32_32x32x16_bf16 v[16:31], v[32:35], v[48:51], v[16:31]
    ds_read_b64_tr_b16 v[44:45], v2 offset:46080
    ds_read_b64_tr_b16 v[46:47], v2 offset:46848
    ds_read_b128 v[60:63], v74 offset:49152
    s_barrier
    s_waitcnt lgkmcnt(6)
    v_mfma_f32_32x32x16_bf16 v[16:31], v[36:39], v[52:55], v[16:31]
    ds_read_b64_tr_b16 v[32:33], v2 offset:49152
    ds_read_b64_tr_b16 v[34:35], v2 offset:49920
    ds_read_b128 v[48:51], v75 offset:0
    s_waitcnt lgkmcnt(6)
    v_mfma_f32_32x32x16_bf16 v[16:31], v[40:43], v[56:59], v[16:31]
    ds_read_b64_tr_b16 v[36:37], v2 offset:52224
    ds_read_b64_tr_b16 v[38:39], v2 offset:52992
    ds_read_b128 v[52:55], v76 offset:0
    s_waitcnt lgkmcnt(6)
    v_mfma_f32_32x32x16_bf16 v[16:31], v[44:47], v[60:63], v[16:31]
    ds_read_b64_tr_b16 v[40:41], v2 offset:55296
    ds_read_b64_tr_b16 v[42:43], v2 offset:56064
    ds_read_b128 v[56:59], v77 offset:0
    s_waitcnt lgkmcnt(6)
    v_mfma_f32_32x32x16_bf16 v[16:31], v[32:35], v[48:51], v[16:31]
    ds_read_b64_tr_b16 v[44:45], v2 offset:58368
    ds_read_b64_tr_b16 v[46:47], v2 offset:59136
    ds_read_b128 v[60:63], v78 offset:0
    s_barrier
    s_waitcnt lgkmcnt(6)
    v_mfma_f32_32x32x16_bf16 v[16:31], v[36:39], v[52:55], v[16:31]
    ds_read_b64_tr_b16 v[32:33], v2 offset:0
    ds_read_b64_tr_b16 v[34:35], v2 offset:768
    ds_read_b128 v[48:51], v71 offset:0
    s_waitcnt lgkmcnt(6)
    v_mfma_f32_32x32x16_bf16 v[16:31], v[40:43], v[56:59], v[16:31]
    ds_read_b64_tr_b16 v[36:37], v2 offset:3072
    ds_read_b64_tr_b16 v[38:39], v2 offset:3840
    ds_read_b128 v[52:55], v72 offset:0
    s_waitcnt lgkmcnt(6)
    v_mfma_f32_32x32x16_bf16 v[16:31], v[44:47], v[60:63], v[16:31]
    ds_read_b64_tr_b16 v[40:41], v2 offset:6144
    ds_read_b64_tr_b16 v[42:43], v2 offset:6912
    ds_read_b128 v[56:59], v73 offset:0
    s_waitcnt lgkmcnt(6)
    v_mfma_f32_32x32x16_bf16 v[16:31], v[32:35], v[48:51], v[16:31]
    ds_read_b64_tr_b16 v[44:45], v2 offset:9216
    ds_read_b64_tr_b16 v[46:47], v2 offset:9984
    ds_read_b128 v[60:63], v74 offset:0
    s_barrier
    s_waitcnt lgkmcnt(6)
    v_mfma_f32_32x32x16_bf16 v[16:31], v[36:39], v[52:55], v[16:31]
    ds_read_b64_tr_b16 v[32:33], v2 offset:12288
    ds_read_b64_tr_b16 v[34:35], v2 offset:13056
    ds_read_b128 v[48:51], v71 offset:16384
    s_waitcnt lgkmcnt(6)
    v_mfma_f32_32x32x16_bf16 v[16:31], v[40:43], v[56:59], v[16:31]
    ds_read_b64_tr_b16 v[36:37], v2 offset:15360
    ds_read_b64_tr_b16 v[38:39], v2 offset:16128
    ds_read_b128 v[52:55], v72 offset:16384
    s_waitcnt lgkmcnt(6)
    v_mfma_f32_32x32x16_bf16 v[16:31], v[44:47], v[60:63], v[16:31]
    ds_read_b64_tr_b16 v[40:41], v2 offset:18432
    ds_read_b64_tr_b16 v[42:43], v2 offset:19200
    ds_read_b128 v[56:59], v73 offset:16384
    s_waitcnt lgkmcnt(6)
    v_mfma_f32_32x32x16_bf16 v[16:31], v[32:35], v[48:51], v[16:31]
    ds_read_b64_tr_b16 v[44:45], v2 offset:21504
    ds_read_b64_tr_b16 v[46:47], v2 offset:22272
    ds_read_b128 v[60:63], v74 offset:16384
    s_barrier
    s_waitcnt lgkmcnt(6)
    v_mfma_f32_32x32x16_bf16 v[16:31], v[36:39], v[52:55], v[16:31]
    ds_read_b64_tr_b16 v[32:33], v2 offset:24576
    ds_read_b64_tr_b16 v[34:35], v2 offset:25344
    ds_read_b128 v[48:51], v71 offset:32768
    s_waitcnt lgkmcnt(6)
    v_mfma_f32_32x32x16_bf16 v[16:31], v[40:43], v[56:59], v[16:31]
    ds_read_b64_tr_b16 v[36:37], v2 offset:27648
    ds_read_b64_tr_b16 v[38:39], v2 offset:28416
    ds_read_b128 v[52:55], v72 offset:32768
    s_waitcnt lgkmcnt(6)
    v_mfma_f32_32x32x16_bf16 v[16:31], v[44:47], v[60:63], v[16:31]
    ds_read_b64_tr_b16 v[40:41], v2 offset:30720
    ds_read_b64_tr_b16 v[42:43], v2 offset:31488
    ds_read_b128 v[56:59], v73 offset:32768
    s_waitcnt lgkmcnt(6)
    v_mfma_f32_32x32x16_bf16 v[16:31], v[32:35], v[48:51], v[16:31]
    ds_read_b64_tr_b16 v[44:45], v2 offset:33792
    ds_read_b64_tr_b16 v[46:47], v2 offset:34560
    ds_read_b128 v[60:63], v74 offset:32768
    s_barrier
    s_waitcnt lgkmcnt(6)
    v_mfma_f32_32x32x16_bf16 v[16:31], v[36:39], v[52:55], v[16:31]
    ds_read_b64_tr_b16 v[32:33], v2 offset:36864
    ds_read_b64_tr_b16 v[34:35], v2 offset:37632
    ds_read_b128 v[48:51], v71 offset:49152
    s_waitcnt lgkmcnt(6)
    v_mfma_f32_32x32x16_bf16 v[16:31], v[40:43], v[56:59], v[16:31]
    ds_read_b64_tr_b16 v[36:37], v2 offset:39936
    ds_read_b64_tr_b16 v[38:39], v2 offset:40704
    ds_read_b128 v[52:55], v72 offset:49152
    s_waitcnt lgkmcnt(6)
    v_mfma_f32_32x32x16_bf16 v[16:31], v[44:47], v[60:63], v[16:31]
    ds_read_b64_tr_b16 v[40:41], v2 offset:43008
    ds_read_b64_tr_b16 v[42:43], v2 offset:43776
    ds_read_b128 v[56:59], v73 offset:49152
    s_waitcnt lgkmcnt(6)
    v_mfma_f32_32x32x16_bf16 v[16:31], v[32:35], v[48:51], v[16:31]
    ds_read_b64_tr_b16 v[44:45], v2 offset:46080
    ds_read_b64_tr_b16 v[46:47], v2 offset:46848
    ds_read_b128 v[60:63], v74 offset:49152
    s_waitcnt lgkmcnt(6)
    v_mfma_f32_32x32x16_bf16 v[16:31], v[36:39], v[52:55], v[16:31]
    s_waitcnt lgkmcnt(3)
    v_mfma_f32_32x32x16_bf16 v[16:31], v[40:43], v[56:59], v[16:31]
    s_waitcnt lgkmcnt(0)
    v_mfma_f32_32x32x16_bf16 v[16:31], v[44:47], v[60:63], v[16:31]
    s_barrier
    s_mov_b32 s28, 0x3eae1a93
    s_nop 12
    v_cvt_pk_bf16_f32 v32, v16, v17
    v_cvt_pk_bf16_f32 v33, v18, v19
    v_cvt_pk_bf16_f32 v34, v20, v21
    v_cvt_pk_bf16_f32 v35, v22, v23
    v_cvt_pk_bf16_f32 v36, v24, v25
    v_cvt_pk_bf16_f32 v37, v26, v27
    v_cvt_pk_bf16_f32 v38, v28, v29
    v_cvt_pk_bf16_f32 v39, v30, v31
    s_nop 1
    v_permlane32_swap_b32 v32, v34
    v_permlane32_swap_b32 v33, v35
    v_permlane32_swap_b32 v36, v38
    v_permlane32_swap_b32 v37, v39
    ds_write_b128 v79, v[32:35] offset:0
    ds_write_b128 v79, v[36:39] offset:32
    s_waitcnt lgkmcnt(0)
    s_branch L_op_fin
L_op_fin:
    s_barrier
    s_mov_b32 s28, 357913942
    s_lshl_b32 s35, s25, 2
    v_mov_b32 v10, 0x7fffff00
    v_add_u32 v6, 0, v0
    v_mul_hi_u32 v7, v6, s28
    v_mul_u32_u24 v8, 12, v7
    v_sub_u32 v8, v6, v8
    v_cmp_gt_u32 vcc, s35, v8
    v_mul_u32_u24 v9, 208, v7
    v_lshl_add_u32 v9, v8, 4, v9
    ds_read_b128 v[16:19], v9
    v_mul_lo_u32 v7, v7, s24
    v_lshl_add_u32 v7, v8, 4, v7
    v_cndmask_b32 v24, v10, v7, vcc
    v_add_u32 v6, 768, v0
    v_mul_hi_u32 v7, v6, s28
    v_mul_u32_u24 v8, 12, v7
    v_sub_u32 v8, v6, v8
    v_cmp_gt_u32 vcc, s35, v8
    v_mul_u32_u24 v9, 208, v7
    v_lshl_add_u32 v9, v8, 4, v9
    ds_read_b128 v[20:23], v9
    v_mul_lo_u32 v7, v7, s24
    v_lshl_add_u32 v7, v8, 4, v7
    v_cndmask_b32 v25, v10, v7, vcc
    s_waitcnt lgkmcnt(1)
    buffer_store_dwordx4 v[16:19], v24, s[16:19], s23 offen
    s_waitcnt lgkmcnt(0)
    buffer_store_dwordx4 v[20:23], v25, s[16:19], s23 offen
L_outp_end:
    s_endpgm
.section .rodata,"a"

.p2align 6
.amdhsa_kernel projb_kernel
  .amdhsa_next_free_vgpr 149
  .amdhsa_next_free_sgpr 102
  .amdhsa_accum_offset 152
  .amdhsa_group_segment_fixed_size 0
  .amdhsa_kernarg_size 88
  .amdhsa_user_sgpr_count 2
  .amdhsa_user_sgpr_kernarg_segment_ptr 1
  .amdhsa_system_sgpr_workgroup_id_x 1
.end_amdhsa_kernel

.p2align 6
.amdhsa_kernel main_kernel
  .amdhsa_next_free_vgpr 128
  .amdhsa_next_free_sgpr 102
  .amdhsa_accum_offset 128
  .amdhsa_group_segment_fixed_size 0
  .amdhsa_kernarg_size 88
  .amdhsa_user_sgpr_count 2
  .amdhsa_user_sgpr_kernarg_segment_ptr 1
  .amdhsa_system_sgpr_workgroup_id_x 1
.end_amdhsa_kernel

.p2align 6
.amdhsa_kernel outp_kernel
  .amdhsa_next_free_vgpr 80
  .amdhsa_next_free_sgpr 102
  .amdhsa_accum_offset 80
  .amdhsa_group_segment_fixed_size 0
  .amdhsa_kernarg_size 88
  .amdhsa_user_sgpr_count 2
  .amdhsa_user_sgpr_kernarg_segment_ptr 1
  .amdhsa_system_sgpr_workgroup_id_x 1
.end_amdhsa_kernel
```
